```python
import torch

def _softmax(x, axis=-1):
    return torch.softmax(x, dim=axis)
def _gelu(x):
    return torch.nn.functional.gelu(x, approximate="tanh")
def _silu(x):
    return torch.nn.functional.silu(x)
def _sigmoid(x):
    return torch.sigmoid(x)
def _layernorm(x, axis=-1, eps=1e-5):
    m = x.mean(dim=axis, keepdim=True)
    v = x.var(dim=axis, keepdim=True, unbiased=False)
    return (x - m) / torch.sqrt(v + eps)
def _scatter_add(tgt, idx, src, axis=0):
    return tgt.clone().index_add_(axis, idx, src)
def _segment_sum(src, seg, n):
    out = torch.zeros((n,) + src.shape[1:], dtype=src.dtype)
    return out.index_add_(0, seg, src)
def _pad(x, pw):
    flat = tuple(v for pair in reversed(pw) for v in pair)
    return torch.nn.functional.pad(x, flat)

kernel_name = 'recurrent_scan__gqa_block_cached__mixer_channel_mlp__decode'

def setup_inputs():

    _w = (lambda a: (lambda t: t.to(torch.bfloat16) if t.is_floating_point() else t)(torch.as_tensor(a)))
    def _A_setup():
        B, Sq, D = 1, 1, 512
        Hq, Hkv, Sk, Dh = 32, 8, 32768, 128
        assert Hq % Hkv == 0, (Hq, Hkv)
        return {
            "x": _w((lambda *s: torch.randn(*s, dtype=torch.bfloat16) * 0.1)(B, Sq, D)),
            "k_cache": _w((lambda *s: torch.randn(*s, dtype=torch.bfloat16) * 0.8)(B, Hkv, Sk, Dh)),
            "v_cache": _w((lambda *s: torch.randn(*s, dtype=torch.bfloat16) * 3.2)(B, Hkv, Sk, Dh)),
            "wq": _w((lambda *s: torch.randn(*s, dtype=torch.bfloat16) * 0.8)(D, Hq * Dh) * (D ** -0.5)),
            "wo": _w((lambda *s: torch.randn(*s, dtype=torch.bfloat16) * 3.2)(Hq * Dh, D) * ((Hq * Dh) ** -0.5)),
        }
    _A_in = _A_setup()

    def _B_setup():
        B, S, D, F = 1, 1, 512, 1792
        return {
            "x": _w((lambda *s: torch.randn(*s, dtype=torch.bfloat16) * 0.1)(B, S, D)),
            "w1": _w((lambda *s: torch.randn(*s, dtype=torch.bfloat16) * 3.2)(D, F) * (D ** -0.5)),
            "b1": _w((lambda *s: torch.randn(*s, dtype=torch.bfloat16) * 3.2)(F)),
            "w2": _w((lambda *s: torch.randn(*s, dtype=torch.bfloat16) * 3.2)(F, D) * (F ** -0.5)),
            "b2": _w((lambda *s: torch.randn(*s, dtype=torch.bfloat16) * 3.2)(D)),
        }
    _B_in = _B_setup()

    return {
        "A_x": _A_in["x"],
        "A_k_cache": _A_in["k_cache"],
        "A_v_cache": _A_in["v_cache"],
        "A_wq": _A_in["wq"],
        "A_wo": _A_in["wo"],
        "B_x": _B_in["x"],
        "B_w1": _B_in["w1"],
        "B_b1": _B_in["b1"],
        "B_w2": _B_in["w2"],
        "B_b2": _B_in["b2"],
    }

def reference(A_x, A_k_cache, A_v_cache, A_wq, A_wo, B_x, B_w1, B_b1, B_w2, B_b2):
    def _A_ref(x, k_cache, v_cache, wq, wo):
        B, Sq, D = x.shape
        Hq, Dh = 32, 128
        Hkv = k_cache.shape[1]
        rep = Hq // Hkv
        q = (lambda x, *d: x.permute(*d))((x @ wq).reshape(B, Sq, Hq, Dh), 0, 2, 1, 3)
        k = (lambda x, n, axis: torch.repeat_interleave(x, n, dim=axis))(k_cache, rep, axis=1)
        v = (lambda x, n, axis: torch.repeat_interleave(x, n, dim=axis))(v_cache, rep, axis=1)
        scores = torch.einsum("bhqd,bhkd->bhqk", q, k) * (Dh ** -0.5)
        p = _softmax(scores, axis=-1)
        o = torch.einsum("bhqk,bhkd->bhqd", p, v)
        return (lambda x, *d: x.permute(*d))(o, 0, 2, 1, 3).reshape(B, Sq, Hq * Dh) @ wo

    def _B_ref(x, w1, b1, w2, b2):
        y = _layernorm(x, axis=-1)
        h = _gelu(torch.einsum("bsd,df->bsf", y, w1) + b1)
        return torch.einsum("bsf,fd->bsd", h, w2) + b2

    x = A_x
    xn = _layernorm(x, axis=-1)
    s = _A_ref(xn, A_k_cache, A_v_cache, A_wq, A_wo)
    g = _silu(_B_ref(xn, B_w1, B_b1, B_w2, B_b2))
    return x + s * g
```

```asm
; @launch kernel=prep_kernel grid=(184,1,1) block=(256,1,1) lds=9216
; @launch kernel=attn_kernel grid=(256,1,1) block=(512,1,1) lds=135168
; @launch kernel=comb_kernel grid=(256,1,1) block=(256,1,1) lds=8192
; @launch kernel=final_kernel grid=(8,1,1) block=(256,1,1) lds=2048
.amdgcn_target "amdgcn-amd-amdhsa--gfx950"
.text
.globl prep_kernel
.p2align 8
.type prep_kernel,@function
prep_kernel:
    s_cmp_ge_u32 s2, 184
    s_cbranch_scc1 K1_END
    s_load_dwordx2 s[4:5], s[0:1], 0
    s_load_dwordx2 s[6:7], s[0:1], 24
    s_load_dwordx2 s[8:9], s[0:1], 48
    s_load_dwordx2 s[10:11], s[0:1], 56
    s_load_dwordx2 s[12:13], s[0:1], 96
    s_mov_b32 s40, 0x7fff
    s_waitcnt lgkmcnt(0)
    s_mov_b32 s16, s4
    s_mov_b32 s17, s5
    s_mov_b32 s18, 1024
    s_mov_b32 s19, 0x00020000
    s_cmp_lt_u32 s2, 128
    s_cbranch_scc0 K1_H
    s_mov_b32 s20, s6
    s_mov_b32 s21, s7
    s_mov_b32 s22, 4194304
    s_mov_b32 s23, 0x00020000
    s_mov_b32 s24, 8192
    s_lshl_b32 s25, s2, 6
    s_branch K1_J
K1_H:
    s_mov_b32 s20, s8
    s_mov_b32 s21, s9
    s_mov_b32 s22, 1835008
    s_mov_b32 s23, 0x00020000
    s_mov_b32 s24, 3584
    s_sub_u32 s25, s2, 128
    s_lshl_b32 s25, s25, 6
K1_J:
    v_and_b32 v1, 3, v0
    v_lshrrev_b32 v2, 2, v0
    v_lshlrev_b32 v3, 3, v2
    v_mul_lo_u32 v3, v3, s24
    v_lshl_add_u32 v3, v1, 4, v3
    v_add_u32 v3, s25, v3
    buffer_load_dwordx4 v[16:19], v3, s[20:23], 0 offen
    v_add_u32 v3, s24, v3
    buffer_load_dwordx4 v[20:23], v3, s[20:23], 0 offen
    v_add_u32 v3, s24, v3
    buffer_load_dwordx4 v[24:27], v3, s[20:23], 0 offen
    v_add_u32 v3, s24, v3
    buffer_load_dwordx4 v[28:31], v3, s[20:23], 0 offen
    v_add_u32 v3, s24, v3
    buffer_load_dwordx4 v[32:35], v3, s[20:23], 0 offen
    v_add_u32 v3, s24, v3
    buffer_load_dwordx4 v[36:39], v3, s[20:23], 0 offen
    v_add_u32 v3, s24, v3
    buffer_load_dwordx4 v[40:43], v3, s[20:23], 0 offen
    v_add_u32 v3, s24, v3
    buffer_load_dwordx4 v[44:47], v3, s[20:23], 0 offen
    v_and_b32 v4, 63, v0
    v_lshlrev_b32 v5, 4, v4
    buffer_load_dwordx4 v[8:11], v5, s[16:19], 0 offen
    v_lshlrev_b32 v6, 4, v2
    buffer_load_dwordx4 v[12:15], v6, s[16:19], 0 offen
    v_lshlrev_b32 v5, 2, v4
    s_waitcnt vmcnt(1)
    v_lshlrev_b32 v48, 16, v8
    v_and_b32 v49, 0xffff0000, v8
    v_lshlrev_b32 v50, 16, v9
    v_and_b32 v51, 0xffff0000, v9
    v_lshlrev_b32 v52, 16, v10
    v_and_b32 v53, 0xffff0000, v10
    v_lshlrev_b32 v54, 16, v11
    v_and_b32 v55, 0xffff0000, v11
    v_add_f32 v7, v48, v49
    v_add_f32 v7, v7, v50
    v_add_f32 v7, v7, v51
    v_add_f32 v7, v7, v52
    v_add_f32 v7, v7, v53
    v_add_f32 v7, v7, v54
    v_add_f32 v7, v7, v55
    v_xor_b32 v57, 4, v5
    ds_bpermute_b32 v56, v57, v7
    s_waitcnt lgkmcnt(0)
    v_add_f32 v7, v7, v56
    v_xor_b32 v57, 8, v5
    ds_bpermute_b32 v56, v57, v7
    s_waitcnt lgkmcnt(0)
    v_add_f32 v7, v7, v56
    v_xor_b32 v57, 16, v5
    ds_bpermute_b32 v56, v57, v7
    s_waitcnt lgkmcnt(0)
    v_add_f32 v7, v7, v56
    v_xor_b32 v57, 32, v5
    ds_bpermute_b32 v56, v57, v7
    s_waitcnt lgkmcnt(0)
    v_add_f32 v7, v7, v56
    v_xor_b32 v57, 64, v5
    ds_bpermute_b32 v56, v57, v7
    s_waitcnt lgkmcnt(0)
    v_add_f32 v7, v7, v56
    v_xor_b32 v57, 128, v5
    ds_bpermute_b32 v56, v57, v7
    s_waitcnt lgkmcnt(0)
    v_add_f32 v7, v7, v56
    v_mul_f32 v60, 0x3b000000, v7
    v_sub_f32 v58, v48, v60
    v_mul_f32 v7, v58, v58
    v_sub_f32 v58, v49, v60
    v_fmac_f32 v7, v58, v58
    v_sub_f32 v58, v50, v60
    v_fmac_f32 v7, v58, v58
    v_sub_f32 v58, v51, v60
    v_fmac_f32 v7, v58, v58
    v_sub_f32 v58, v52, v60
    v_fmac_f32 v7, v58, v58
    v_sub_f32 v58, v53, v60
    v_fmac_f32 v7, v58, v58
    v_sub_f32 v58, v54, v60
    v_fmac_f32 v7, v58, v58
    v_sub_f32 v58, v55, v60
    v_fmac_f32 v7, v58, v58
    v_xor_b32 v57, 4, v5
    ds_bpermute_b32 v56, v57, v7
    s_waitcnt lgkmcnt(0)
    v_add_f32 v7, v7, v56
    v_xor_b32 v57, 8, v5
    ds_bpermute_b32 v56, v57, v7
    s_waitcnt lgkmcnt(0)
    v_add_f32 v7, v7, v56
    v_xor_b32 v57, 16, v5
    ds_bpermute_b32 v56, v57, v7
    s_waitcnt lgkmcnt(0)
    v_add_f32 v7, v7, v56
    v_xor_b32 v57, 32, v5
    ds_bpermute_b32 v56, v57, v7
    s_waitcnt lgkmcnt(0)
    v_add_f32 v7, v7, v56
    v_xor_b32 v57, 64, v5
    ds_bpermute_b32 v56, v57, v7
    s_waitcnt lgkmcnt(0)
    v_add_f32 v7, v7, v56
    v_xor_b32 v57, 128, v5
    ds_bpermute_b32 v56, v57, v7
    s_waitcnt lgkmcnt(0)
    v_add_f32 v7, v7, v56
    v_mov_b32 v58, 0x3727c5ac
    v_fmac_f32 v58, 0x3b000000, v7
    v_rsq_f32 v61, v58
    s_nop 0
    v_sub_f32 v48, v48, v60
    v_mul_f32 v48, v48, v61
    v_bfe_u32 v58, v48, 16, 1
    v_add3_u32 v48, v48, v58, s40
    v_and_b32 v48, 0xffff0000, v48
    v_sub_f32 v49, v49, v60
    v_mul_f32 v49, v49, v61
    v_bfe_u32 v58, v49, 16, 1
    v_add3_u32 v49, v49, v58, s40
    v_and_b32 v49, 0xffff0000, v49
    v_sub_f32 v50, v50, v60
    v_mul_f32 v50, v50, v61
    v_bfe_u32 v58, v50, 16, 1
    v_add3_u32 v50, v50, v58, s40
    v_and_b32 v50, 0xffff0000, v50
    v_sub_f32 v51, v51, v60
    v_mul_f32 v51, v51, v61
    v_bfe_u32 v58, v51, 16, 1
    v_add3_u32 v51, v51, v58, s40
    v_and_b32 v51, 0xffff0000, v51
    v_sub_f32 v52, v52, v60
    v_mul_f32 v52, v52, v61
    v_bfe_u32 v58, v52, 16, 1
    v_add3_u32 v52, v52, v58, s40
    v_and_b32 v52, 0xffff0000, v52
    v_sub_f32 v53, v53, v60
    v_mul_f32 v53, v53, v61
    v_bfe_u32 v58, v53, 16, 1
    v_add3_u32 v53, v53, v58, s40
    v_and_b32 v53, 0xffff0000, v53
    v_sub_f32 v54, v54, v60
    v_mul_f32 v54, v54, v61
    v_bfe_u32 v58, v54, 16, 1
    v_add3_u32 v54, v54, v58, s40
    v_and_b32 v54, 0xffff0000, v54
    v_sub_f32 v55, v55, v60
    v_mul_f32 v55, v55, v61
    v_bfe_u32 v58, v55, 16, 1
    v_add3_u32 v55, v55, v58, s40
    v_and_b32 v55, 0xffff0000, v55
    s_waitcnt vmcnt(0)
    v_lshlrev_b32 v64, 16, v12
    v_and_b32 v65, 0xffff0000, v12
    v_lshlrev_b32 v66, 16, v13
    v_and_b32 v67, 0xffff0000, v13
    v_lshlrev_b32 v68, 16, v14
    v_and_b32 v69, 0xffff0000, v14
    v_lshlrev_b32 v70, 16, v15
    v_and_b32 v71, 0xffff0000, v15
    v_sub_f32 v64, v64, v60
    v_mul_f32 v64, v64, v61
    v_bfe_u32 v58, v64, 16, 1
    v_add3_u32 v64, v64, v58, s40
    v_and_b32 v64, 0xffff0000, v64
    v_sub_f32 v65, v65, v60
    v_mul_f32 v65, v65, v61
    v_bfe_u32 v58, v65, 16, 1
    v_add3_u32 v65, v65, v58, s40
    v_and_b32 v65, 0xffff0000, v65
    v_sub_f32 v66, v66, v60
    v_mul_f32 v66, v66, v61
    v_bfe_u32 v58, v66, 16, 1
    v_add3_u32 v66, v66, v58, s40
    v_and_b32 v66, 0xffff0000, v66
    v_sub_f32 v67, v67, v60
    v_mul_f32 v67, v67, v61
    v_bfe_u32 v58, v67, 16, 1
    v_add3_u32 v67, v67, v58, s40
    v_and_b32 v67, 0xffff0000, v67
    v_sub_f32 v68, v68, v60
    v_mul_f32 v68, v68, v61
    v_bfe_u32 v58, v68, 16, 1
    v_add3_u32 v68, v68, v58, s40
    v_and_b32 v68, 0xffff0000, v68
    v_sub_f32 v69, v69, v60
    v_mul_f32 v69, v69, v61
    v_bfe_u32 v58, v69, 16, 1
    v_add3_u32 v69, v69, v58, s40
    v_and_b32 v69, 0xffff0000, v69
    v_sub_f32 v70, v70, v60
    v_mul_f32 v70, v70, v61
    v_bfe_u32 v58, v70, 16, 1
    v_add3_u32 v70, v70, v58, s40
    v_and_b32 v70, 0xffff0000, v70
    v_sub_f32 v71, v71, v60
    v_mul_f32 v71, v71, v61
    v_bfe_u32 v58, v71, 16, 1
    v_add3_u32 v71, v71, v58, s40
    v_and_b32 v71, 0xffff0000, v71
    s_cmp_lt_u32 s2, 128
    s_cbranch_scc1 K1_NOLN2
    v_add_f32 v7, v48, v49
    v_add_f32 v7, v7, v50
    v_add_f32 v7, v7, v51
    v_add_f32 v7, v7, v52
    v_add_f32 v7, v7, v53
    v_add_f32 v7, v7, v54
    v_add_f32 v7, v7, v55
    v_xor_b32 v57, 4, v5
    ds_bpermute_b32 v56, v57, v7
    s_waitcnt lgkmcnt(0)
    v_add_f32 v7, v7, v56
    v_xor_b32 v57, 8, v5
    ds_bpermute_b32 v56, v57, v7
    s_waitcnt lgkmcnt(0)
    v_add_f32 v7, v7, v56
    v_xor_b32 v57, 16, v5
    ds_bpermute_b32 v56, v57, v7
    s_waitcnt lgkmcnt(0)
    v_add_f32 v7, v7, v56
    v_xor_b32 v57, 32, v5
    ds_bpermute_b32 v56, v57, v7
    s_waitcnt lgkmcnt(0)
    v_add_f32 v7, v7, v56
    v_xor_b32 v57, 64, v5
    ds_bpermute_b32 v56, v57, v7
    s_waitcnt lgkmcnt(0)
    v_add_f32 v7, v7, v56
    v_xor_b32 v57, 128, v5
    ds_bpermute_b32 v56, v57, v7
    s_waitcnt lgkmcnt(0)
    v_add_f32 v7, v7, v56
    v_mul_f32 v62, 0x3b000000, v7
    v_sub_f32 v58, v48, v62
    v_mul_f32 v7, v58, v58
    v_sub_f32 v58, v49, v62
    v_fmac_f32 v7, v58, v58
    v_sub_f32 v58, v50, v62
    v_fmac_f32 v7, v58, v58
    v_sub_f32 v58, v51, v62
    v_fmac_f32 v7, v58, v58
    v_sub_f32 v58, v52, v62
    v_fmac_f32 v7, v58, v58
    v_sub_f32 v58, v53, v62
    v_fmac_f32 v7, v58, v58
    v_sub_f32 v58, v54, v62
    v_fmac_f32 v7, v58, v58
    v_sub_f32 v58, v55, v62
    v_fmac_f32 v7, v58, v58
    v_xor_b32 v57, 4, v5
    ds_bpermute_b32 v56, v57, v7
    s_waitcnt lgkmcnt(0)
    v_add_f32 v7, v7, v56
    v_xor_b32 v57, 8, v5
    ds_bpermute_b32 v56, v57, v7
    s_waitcnt lgkmcnt(0)
    v_add_f32 v7, v7, v56
    v_xor_b32 v57, 16, v5
    ds_bpermute_b32 v56, v57, v7
    s_waitcnt lgkmcnt(0)
    v_add_f32 v7, v7, v56
    v_xor_b32 v57, 32, v5
    ds_bpermute_b32 v56, v57, v7
    s_waitcnt lgkmcnt(0)
    v_add_f32 v7, v7, v56
    v_xor_b32 v57, 64, v5
    ds_bpermute_b32 v56, v57, v7
    s_waitcnt lgkmcnt(0)
    v_add_f32 v7, v7, v56
    v_xor_b32 v57, 128, v5
    ds_bpermute_b32 v56, v57, v7
    s_waitcnt lgkmcnt(0)
    v_add_f32 v7, v7, v56
    v_mov_b32 v58, 0x3727c5ac
    v_fmac_f32 v58, 0x3b000000, v7
    v_rsq_f32 v63, v58
    s_nop 0
    v_sub_f32 v64, v64, v62
    v_mul_f32 v64, v64, v63
    v_bfe_u32 v58, v64, 16, 1
    v_add3_u32 v64, v64, v58, s40
    v_and_b32 v64, 0xffff0000, v64
    v_sub_f32 v65, v65, v62
    v_mul_f32 v65, v65, v63
    v_bfe_u32 v58, v65, 16, 1
    v_add3_u32 v65, v65, v58, s40
    v_and_b32 v65, 0xffff0000, v65
    v_sub_f32 v66, v66, v62
    v_mul_f32 v66, v66, v63
    v_bfe_u32 v58, v66, 16, 1
    v_add3_u32 v66, v66, v58, s40
    v_and_b32 v66, 0xffff0000, v66
    v_sub_f32 v67, v67, v62
    v_mul_f32 v67, v67, v63
    v_bfe_u32 v58, v67, 16, 1
    v_add3_u32 v67, v67, v58, s40
    v_and_b32 v67, 0xffff0000, v67
    v_sub_f32 v68, v68, v62
    v_mul_f32 v68, v68, v63
    v_bfe_u32 v58, v68, 16, 1
    v_add3_u32 v68, v68, v58, s40
    v_and_b32 v68, 0xffff0000, v68
    v_sub_f32 v69, v69, v62
    v_mul_f32 v69, v69, v63
    v_bfe_u32 v58, v69, 16, 1
    v_add3_u32 v69, v69, v58, s40
    v_and_b32 v69, 0xffff0000, v69
    v_sub_f32 v70, v70, v62
    v_mul_f32 v70, v70, v63
    v_bfe_u32 v58, v70, 16, 1
    v_add3_u32 v70, v70, v58, s40
    v_and_b32 v70, 0xffff0000, v70
    v_sub_f32 v71, v71, v62
    v_mul_f32 v71, v71, v63
    v_bfe_u32 v58, v71, 16, 1
    v_add3_u32 v71, v71, v58, s40
    v_and_b32 v71, 0xffff0000, v71
K1_NOLN2:
    v_mov_b32 v72, 0
    v_mov_b32 v73, 0
    v_mov_b32 v74, 0
    v_mov_b32 v75, 0
    v_mov_b32 v76, 0
    v_mov_b32 v77, 0
    v_mov_b32 v78, 0
    v_mov_b32 v79, 0
    v_lshlrev_b32 v80, 16, v16
    v_and_b32 v81, 0xffff0000, v16
    v_lshlrev_b32 v82, 16, v17
    v_and_b32 v83, 0xffff0000, v17
    v_lshlrev_b32 v84, 16, v18
    v_and_b32 v85, 0xffff0000, v18
    v_lshlrev_b32 v86, 16, v19
    v_and_b32 v87, 0xffff0000, v19
    v_fmac_f32 v72, v64, v80
    v_fmac_f32 v73, v64, v81
    v_fmac_f32 v74, v64, v82
    v_fmac_f32 v75, v64, v83
    v_fmac_f32 v76, v64, v84
    v_fmac_f32 v77, v64, v85
    v_fmac_f32 v78, v64, v86
    v_fmac_f32 v79, v64, v87
    v_lshlrev_b32 v80, 16, v20
    v_and_b32 v81, 0xffff0000, v20
    v_lshlrev_b32 v82, 16, v21
    v_and_b32 v83, 0xffff0000, v21
    v_lshlrev_b32 v84, 16, v22
    v_and_b32 v85, 0xffff0000, v22
    v_lshlrev_b32 v86, 16, v23
    v_and_b32 v87, 0xffff0000, v23
    v_fmac_f32 v72, v65, v80
    v_fmac_f32 v73, v65, v81
    v_fmac_f32 v74, v65, v82
    v_fmac_f32 v75, v65, v83
    v_fmac_f32 v76, v65, v84
    v_fmac_f32 v77, v65, v85
    v_fmac_f32 v78, v65, v86
    v_fmac_f32 v79, v65, v87
    v_lshlrev_b32 v80, 16, v24
    v_and_b32 v81, 0xffff0000, v24
    v_lshlrev_b32 v82, 16, v25
    v_and_b32 v83, 0xffff0000, v25
    v_lshlrev_b32 v84, 16, v26
    v_and_b32 v85, 0xffff0000, v26
    v_lshlrev_b32 v86, 16, v27
    v_and_b32 v87, 0xffff0000, v27
    v_fmac_f32 v72, v66, v80
    v_fmac_f32 v73, v66, v81
    v_fmac_f32 v74, v66, v82
    v_fmac_f32 v75, v66, v83
    v_fmac_f32 v76, v66, v84
    v_fmac_f32 v77, v66, v85
    v_fmac_f32 v78, v66, v86
    v_fmac_f32 v79, v66, v87
    v_lshlrev_b32 v80, 16, v28
    v_and_b32 v81, 0xffff0000, v28
    v_lshlrev_b32 v82, 16, v29
    v_and_b32 v83, 0xffff0000, v29
    v_lshlrev_b32 v84, 16, v30
    v_and_b32 v85, 0xffff0000, v30
    v_lshlrev_b32 v86, 16, v31
    v_and_b32 v87, 0xffff0000, v31
    v_fmac_f32 v72, v67, v80
    v_fmac_f32 v73, v67, v81
    v_fmac_f32 v74, v67, v82
    v_fmac_f32 v75, v67, v83
    v_fmac_f32 v76, v67, v84
    v_fmac_f32 v77, v67, v85
    v_fmac_f32 v78, v67, v86
    v_fmac_f32 v79, v67, v87
    v_lshlrev_b32 v80, 16, v32
    v_and_b32 v81, 0xffff0000, v32
    v_lshlrev_b32 v82, 16, v33
    v_and_b32 v83, 0xffff0000, v33
    v_lshlrev_b32 v84, 16, v34
    v_and_b32 v85, 0xffff0000, v34
    v_lshlrev_b32 v86, 16, v35
    v_and_b32 v87, 0xffff0000, v35
    v_fmac_f32 v72, v68, v80
    v_fmac_f32 v73, v68, v81
    v_fmac_f32 v74, v68, v82
    v_fmac_f32 v75, v68, v83
    v_fmac_f32 v76, v68, v84
    v_fmac_f32 v77, v68, v85
    v_fmac_f32 v78, v68, v86
    v_fmac_f32 v79, v68, v87
    v_lshlrev_b32 v80, 16, v36
    v_and_b32 v81, 0xffff0000, v36
    v_lshlrev_b32 v82, 16, v37
    v_and_b32 v83, 0xffff0000, v37
    v_lshlrev_b32 v84, 16, v38
    v_and_b32 v85, 0xffff0000, v38
    v_lshlrev_b32 v86, 16, v39
    v_and_b32 v87, 0xffff0000, v39
    v_fmac_f32 v72, v69, v80
    v_fmac_f32 v73, v69, v81
    v_fmac_f32 v74, v69, v82
    v_fmac_f32 v75, v69, v83
    v_fmac_f32 v76, v69, v84
    v_fmac_f32 v77, v69, v85
    v_fmac_f32 v78, v69, v86
    v_fmac_f32 v79, v69, v87
    v_lshlrev_b32 v80, 16, v40
    v_and_b32 v81, 0xffff0000, v40
    v_lshlrev_b32 v82, 16, v41
    v_and_b32 v83, 0xffff0000, v41
    v_lshlrev_b32 v84, 16, v42
    v_and_b32 v85, 0xffff0000, v42
    v_lshlrev_b32 v86, 16, v43
    v_and_b32 v87, 0xffff0000, v43
    v_fmac_f32 v72, v70, v80
    v_fmac_f32 v73, v70, v81
    v_fmac_f32 v74, v70, v82
    v_fmac_f32 v75, v70, v83
    v_fmac_f32 v76, v70, v84
    v_fmac_f32 v77, v70, v85
    v_fmac_f32 v78, v70, v86
    v_fmac_f32 v79, v70, v87
    v_lshlrev_b32 v80, 16, v44
    v_and_b32 v81, 0xffff0000, v44
    v_lshlrev_b32 v82, 16, v45
    v_and_b32 v83, 0xffff0000, v45
    v_lshlrev_b32 v84, 16, v46
    v_and_b32 v85, 0xffff0000, v46
    v_lshlrev_b32 v86, 16, v47
    v_and_b32 v87, 0xffff0000, v47
    v_fmac_f32 v72, v71, v80
    v_fmac_f32 v73, v71, v81
    v_fmac_f32 v74, v71, v82
    v_fmac_f32 v75, v71, v83
    v_fmac_f32 v76, v71, v84
    v_fmac_f32 v77, v71, v85
    v_fmac_f32 v78, v71, v86
    v_fmac_f32 v79, v71, v87
    v_lshlrev_b32 v6, 7, v2
    v_lshl_add_u32 v6, v1, 5, v6
    ds_write_b128 v6, v[72:75]
    ds_write_b128 v6, v[76:79] offset:16
    s_waitcnt lgkmcnt(0)
    s_barrier
    v_and_b32 v1, 31, v0
    v_lshrrev_b32 v2, 5, v0
    v_lshlrev_b32 v6, 10, v2
    v_lshl_add_u32 v6, v1, 2, v6
    ds_read_b32 v16, v6 offset:0
    ds_read_b32 v17, v6 offset:128
    ds_read_b32 v18, v6 offset:256
    ds_read_b32 v19, v6 offset:384
    ds_read_b32 v20, v6 offset:512
    ds_read_b32 v21, v6 offset:640
    ds_read_b32 v22, v6 offset:768
    ds_read_b32 v23, v6 offset:896
    s_waitcnt lgkmcnt(0)
    v_add_f32 v16, v16, v17
    v_add_f32 v16, v16, v18
    v_add_f32 v16, v16, v19
    v_add_f32 v16, v16, v20
    v_add_f32 v16, v16, v21
    v_add_f32 v16, v16, v22
    v_add_f32 v16, v16, v23
    v_lshlrev_b32 v6, 2, v0
    ds_write_b32 v6, v16 offset:8192
    s_waitcnt lgkmcnt(0)
    s_barrier
    v_cmp_gt_u32 vcc, 32, v0
    s_and_saveexec_b64 s[30:31], vcc
    s_cbranch_execz K1_END
    ds_read_b32 v16, v6 offset:8192
    ds_read_b32 v17, v6 offset:8320
    ds_read_b32 v18, v6 offset:8448
    ds_read_b32 v19, v6 offset:8576
    ds_read_b32 v20, v6 offset:8704
    ds_read_b32 v21, v6 offset:8832
    ds_read_b32 v22, v6 offset:8960
    ds_read_b32 v23, v6 offset:9088
    s_waitcnt lgkmcnt(0)
    v_add_f32 v16, v16, v17
    v_add_f32 v16, v16, v18
    v_add_f32 v16, v16, v19
    v_add_f32 v16, v16, v20
    v_add_f32 v16, v16, v21
    v_add_f32 v16, v16, v22
    v_add_f32 v16, v16, v23
    s_cmp_lt_u32 s2, 128
    s_cbranch_scc0 K1_HOUT
    s_add_u32 s32, s12, 0
    s_addc_u32 s33, s13, 0
    s_mov_b32 s34, 8192
    s_mov_b32 s35, 0x00020000
    v_bfe_u32 v17, v16, 16, 1
    v_add3_u32 v16, v16, v17, s40
    v_and_b32 v16, 0xffff0000, v16
    v_lshrrev_b32 v16, 16, v16
    v_lshlrev_b32 v6, 1, v0
    s_lshl_b32 s26, s2, 6
    v_add_u32 v6, s26, v6
    buffer_store_short v16, v6, s[32:35], 0 offen
    s_branch K1_END
K1_HOUT:
    s_mov_b32 s32, s10
    s_mov_b32 s33, s11
    s_mov_b32 s34, 3584
    s_mov_b32 s35, 0x00020000
    v_lshlrev_b32 v6, 1, v0
    v_add_u32 v6, s25, v6
    buffer_load_ushort v17, v6, s[32:35], 0 offen
    s_add_u32 s36, s12, 16384
    s_addc_u32 s37, s13, 0
    s_mov_b32 s38, 7168
    s_mov_b32 s39, 0x00020000
    s_waitcnt vmcnt(0)
    v_lshlrev_b32 v17, 16, v17
    v_add_f32 v16, v16, v17
    v_mul_f32 v17, v16, v16
    v_mul_f32 v17, v17, v16
    v_mov_b32 v18, 0x3d372713
    v_fma_f32 v17, v17, v18, v16
    v_mul_f32 v17, 0x40135761, v17
    v_exp_f32 v17, v17
    s_nop 0
    v_add_f32 v17, 1.0, v17
    v_rcp_f32 v17, v17
    s_nop 0
    v_fma_f32 v17, v17, -2.0, 1.0
    v_add_f32 v17, 1.0, v17
    v_mul_f32 v16, v16, v17
    v_mul_f32 v16, 0.5, v16
    v_lshlrev_b32 v6, 1, v6
    buffer_store_dword v16, v6, s[36:39], 0 offen
K1_END:
    s_endpgm
.globl attn_kernel
.p2align 8
.type attn_kernel,@function
attn_kernel:
    s_cmp_ge_u32 s2, 256
    s_cbranch_scc1 K2_END
    s_load_dwordx2 s[4:5], s[0:1], 8
    s_load_dwordx2 s[6:7], s[0:1], 16
    s_load_dwordx2 s[8:9], s[0:1], 96
    v_lshrrev_b32 v1, 6, v0
    s_nop 0
    v_readfirstlane_b32 s3, v1
    s_lshr_b32 s10, s2, 5
    s_and_b32 s11, s2, 31
    s_lshl_b32 s12, s10, 23
    s_lshl_b32 s13, s11, 18
    s_lshl_b32 s14, s3, 15
    s_add_u32 s13, s13, s14
    s_waitcnt lgkmcnt(0)
    s_add_u32 s16, s4, s12
    s_addc_u32 s17, s5, 0
    s_mov_b32 s18, 8388608
    s_mov_b32 s19, 0x00020000
    s_add_u32 s20, s6, s12
    s_addc_u32 s21, s7, 0
    s_mov_b32 s22, 8388608
    s_mov_b32 s23, 0x00020000
    s_add_u32 s24, s8, 0
    s_addc_u32 s25, s9, 0
    s_mov_b32 s26, 8192
    s_mov_b32 s27, 0x00020000
    v_and_b32 v2, 63, v0
    v_lshrrev_b32 v3, 4, v2
    v_and_b32 v4, 15, v2
    s_lshl_b32 s15, s10, 10
    v_lshlrev_b32 v5, 8, v4
    v_lshl_add_u32 v5, v3, 4, v5
    v_add_u32 v5, s15, v5
    v_mov_b32 v6, 0x10000000
    v_cmp_gt_u32 vcc, 4, v4
    s_nop 1
    v_cndmask_b32 v5, v6, v5, vcc
    buffer_load_dwordx4 v[16:19], v5, s[24:27], 0 offen offset:0
    buffer_load_dwordx4 v[20:23], v5, s[24:27], 0 offen offset:64
    buffer_load_dwordx4 v[24:27], v5, s[24:27], 0 offen offset:128
    buffer_load_dwordx4 v[28:31], v5, s[24:27], 0 offen offset:192
    v_lshlrev_b32 v5, 8, v4
    v_lshl_add_u32 v5, v3, 4, v5
    v_add_u32 v5, s13, v5
    buffer_load_dwordx4 v[64:67], v5, s[16:19], 0 offen offset:0 nt
    buffer_load_dwordx4 v[68:71], v5, s[16:19], 0 offen offset:64 nt
    buffer_load_dwordx4 v[72:75], v5, s[16:19], 0 offen offset:128 nt
    buffer_load_dwordx4 v[76:79], v5, s[16:19], 0 offen offset:192 nt
    v_add_u32 v5, 0x1000, v5
    buffer_load_dwordx4 v[80:83], v5, s[16:19], 0 offen offset:0 nt
    buffer_load_dwordx4 v[84:87], v5, s[16:19], 0 offen offset:64 nt
    buffer_load_dwordx4 v[88:91], v5, s[16:19], 0 offen offset:128 nt
    buffer_load_dwordx4 v[92:95], v5, s[16:19], 0 offen offset:192 nt
    v_add_u32 v5, 0x1000, v5
    buffer_load_dwordx4 v[96:99], v5, s[16:19], 0 offen offset:0 nt
    buffer_load_dwordx4 v[100:103], v5, s[16:19], 0 offen offset:64 nt
    buffer_load_dwordx4 v[104:107], v5, s[16:19], 0 offen offset:128 nt
    buffer_load_dwordx4 v[108:111], v5, s[16:19], 0 offen offset:192 nt
    v_add_u32 v5, 0x1000, v5
    buffer_load_dwordx4 v[112:115], v5, s[16:19], 0 offen offset:0 nt
    buffer_load_dwordx4 v[116:119], v5, s[16:19], 0 offen offset:64 nt
    buffer_load_dwordx4 v[120:123], v5, s[16:19], 0 offen offset:128 nt
    buffer_load_dwordx4 v[124:127], v5, s[16:19], 0 offen offset:192 nt
    v_add_u32 v5, 0x1000, v5
    buffer_load_dwordx4 v[128:131], v5, s[16:19], 0 offen offset:0 nt
    buffer_load_dwordx4 v[132:135], v5, s[16:19], 0 offen offset:64 nt
    buffer_load_dwordx4 v[136:139], v5, s[16:19], 0 offen offset:128 nt
    buffer_load_dwordx4 v[140:143], v5, s[16:19], 0 offen offset:192 nt
    v_add_u32 v5, 0x1000, v5
    buffer_load_dwordx4 v[144:147], v5, s[16:19], 0 offen offset:0 nt
    buffer_load_dwordx4 v[148:151], v5, s[16:19], 0 offen offset:64 nt
    buffer_load_dwordx4 v[152:155], v5, s[16:19], 0 offen offset:128 nt
    buffer_load_dwordx4 v[156:159], v5, s[16:19], 0 offen offset:192 nt
    v_add_u32 v5, 0x1000, v5
    buffer_load_dwordx4 v[160:163], v5, s[16:19], 0 offen offset:0 nt
    buffer_load_dwordx4 v[164:167], v5, s[16:19], 0 offen offset:64 nt
    buffer_load_dwordx4 v[168:171], v5, s[16:19], 0 offen offset:128 nt
    buffer_load_dwordx4 v[172:175], v5, s[16:19], 0 offen offset:192 nt
    v_add_u32 v5, 0x1000, v5
    buffer_load_dwordx4 v[176:179], v5, s[16:19], 0 offen offset:0 nt
    buffer_load_dwordx4 v[180:183], v5, s[16:19], 0 offen offset:64 nt
    buffer_load_dwordx4 v[184:187], v5, s[16:19], 0 offen offset:128 nt
    buffer_load_dwordx4 v[188:191], v5, s[16:19], 0 offen offset:192 nt
    v_lshlrev_b32 v6, 1, v3
    v_xor_b32 v7, v4, v6
    v_xor_b32 v8, 8, v7
    v_lshlrev_b32 v9, 8, v3
    v_add_u32 v9, s13, v9
    v_lshl_add_u32 v7, v7, 4, v9
    v_lshl_add_u32 v8, v8, 4, v9
    s_lshl_b32 s28, s3, 14
    s_add_u32 s29, s28, 0
    s_mov_b32 m0, s29
    s_mov_b32 s30, 0
    buffer_load_dwordx4 v7, s[20:23], s30 offen offset:0 nt lds
    buffer_load_dwordx4 v8, s[20:23], s30 offen offset:1024 nt lds
    buffer_load_dwordx4 v7, s[20:23], s30 offen offset:2048 nt lds
    buffer_load_dwordx4 v8, s[20:23], s30 offen offset:3072 nt lds
    s_add_u32 s29, s28, 4096
    s_mov_b32 m0, s29
    s_mov_b32 s30, 4096
    buffer_load_dwordx4 v7, s[20:23], s30 offen offset:0 nt lds
    buffer_load_dwordx4 v8, s[20:23], s30 offen offset:1024 nt lds
    buffer_load_dwordx4 v7, s[20:23], s30 offen offset:2048 nt lds
    buffer_load_dwordx4 v8, s[20:23], s30 offen offset:3072 nt lds
    s_add_u32 s29, s28, 8192
    s_mov_b32 m0, s29
    s_mov_b32 s30, 8192
    buffer_load_dwordx4 v7, s[20:23], s30 offen offset:0 nt lds
    buffer_load_dwordx4 v8, s[20:23], s30 offen offset:1024 nt lds
    buffer_load_dwordx4 v7, s[20:23], s30 offen offset:2048 nt lds
    buffer_load_dwordx4 v8, s[20:23], s30 offen offset:3072 nt lds
    s_add_u32 s29, s28, 12288
    s_mov_b32 m0, s29
    s_mov_b32 s30, 12288
    buffer_load_dwordx4 v7, s[20:23], s30 offen offset:0 nt lds
    buffer_load_dwordx4 v8, s[20:23], s30 offen offset:1024 nt lds
    buffer_load_dwordx4 v7, s[20:23], s30 offen offset:2048 nt lds
    buffer_load_dwordx4 v8, s[20:23], s30 offen offset:3072 nt lds
    v_lshrrev_b32 v10, 2, v4
    v_lshl_add_u32 v10, v3, 2, v10
    v_and_b32 v11, 7, v10
    v_lshlrev_b32 v11, 1, v11
    v_bfe_u32 v12, v4, 1, 1
    v_and_b32 v13, 1, v4
    v_lshlrev_b32 v14, 8, v10
    v_lshl_add_u32 v14, v13, 3, v14
    v_add_u32 v14, s28, v14
    v_add_u32 v15, 0, v12
    v_xor_b32 v15, v15, v11
    v_lshl_add_u32 v200, v15, 4, v14
    v_add_u32 v15, 2, v12
    v_xor_b32 v15, v15, v11
    v_lshl_add_u32 v201, v15, 4, v14
    v_add_u32 v15, 4, v12
    v_xor_b32 v15, v15, v11
    v_lshl_add_u32 v202, v15, 4, v14
    v_add_u32 v15, 6, v12
    v_xor_b32 v15, v15, v11
    v_lshl_add_u32 v203, v15, 4, v14
    v_add_u32 v15, 8, v12
    v_xor_b32 v15, v15, v11
    v_lshl_add_u32 v204, v15, 4, v14
    v_add_u32 v15, 10, v12
    v_xor_b32 v15, v15, v11
    v_lshl_add_u32 v205, v15, 4, v14
    v_add_u32 v15, 12, v12
    v_xor_b32 v15, v15, v11
    v_lshl_add_u32 v206, v15, 4, v14
    v_add_u32 v15, 14, v12
    v_xor_b32 v15, v15, v11
    v_lshl_add_u32 v207, v15, 4, v14
    v_mov_b32 v224, 0
    v_mov_b32 v225, 0
    v_mov_b32 v226, 0
    v_mov_b32 v227, 0
    v_mov_b32 v228, 0
    v_mov_b32 v229, 0
    v_mov_b32 v230, 0
    v_mov_b32 v231, 0
    v_mov_b32 v232, 0
    v_mov_b32 v233, 0
    v_mov_b32 v234, 0
    v_mov_b32 v235, 0
    v_mov_b32 v236, 0
    v_mov_b32 v237, 0
    v_mov_b32 v238, 0
    v_mov_b32 v239, 0
    v_mov_b32 v240, 0
    v_mov_b32 v241, 0
    v_mov_b32 v242, 0
    v_mov_b32 v243, 0
    v_mov_b32 v244, 0
    v_mov_b32 v245, 0
    v_mov_b32 v246, 0
    v_mov_b32 v247, 0
    v_mov_b32 v248, 0
    v_mov_b32 v249, 0
    v_mov_b32 v250, 0
    v_mov_b32 v251, 0
    v_mov_b32 v252, 0
    v_mov_b32 v253, 0
    v_mov_b32 v254, 0
    v_mov_b32 v255, 0
    s_waitcnt vmcnt(44)
    v_mfma_f32_16x16x32_bf16 v[32:35], v[64:67], v[16:19], 0
    v_mfma_f32_16x16x32_bf16 v[32:35], v[68:71], v[20:23], v[32:35]
    v_mfma_f32_16x16x32_bf16 v[32:35], v[72:75], v[24:27], v[32:35]
    v_mfma_f32_16x16x32_bf16 v[32:35], v[76:79], v[28:31], v[32:35]
    s_waitcnt vmcnt(40)
    v_mfma_f32_16x16x32_bf16 v[36:39], v[80:83], v[16:19], 0
    v_mfma_f32_16x16x32_bf16 v[36:39], v[84:87], v[20:23], v[36:39]
    v_mfma_f32_16x16x32_bf16 v[36:39], v[88:91], v[24:27], v[36:39]
    v_mfma_f32_16x16x32_bf16 v[36:39], v[92:95], v[28:31], v[36:39]
    s_waitcnt vmcnt(36)
    v_mfma_f32_16x16x32_bf16 v[40:43], v[96:99], v[16:19], 0
    v_mfma_f32_16x16x32_bf16 v[40:43], v[100:103], v[20:23], v[40:43]
    v_mfma_f32_16x16x32_bf16 v[40:43], v[104:107], v[24:27], v[40:43]
    v_mfma_f32_16x16x32_bf16 v[40:43], v[108:111], v[28:31], v[40:43]
    s_waitcnt vmcnt(32)
    v_mfma_f32_16x16x32_bf16 v[44:47], v[112:115], v[16:19], 0
    v_mfma_f32_16x16x32_bf16 v[44:47], v[116:119], v[20:23], v[44:47]
    v_mfma_f32_16x16x32_bf16 v[44:47], v[120:123], v[24:27], v[44:47]
    v_mfma_f32_16x16x32_bf16 v[44:47], v[124:127], v[28:31], v[44:47]
    s_waitcnt vmcnt(28)
    v_mfma_f32_16x16x32_bf16 v[48:51], v[128:131], v[16:19], 0
    v_mfma_f32_16x16x32_bf16 v[48:51], v[132:135], v[20:23], v[48:51]
    v_mfma_f32_16x16x32_bf16 v[48:51], v[136:139], v[24:27], v[48:51]
    v_mfma_f32_16x16x32_bf16 v[48:51], v[140:143], v[28:31], v[48:51]
    s_waitcnt vmcnt(24)
    v_mfma_f32_16x16x32_bf16 v[52:55], v[144:147], v[16:19], 0
    v_mfma_f32_16x16x32_bf16 v[52:55], v[148:151], v[20:23], v[52:55]
    v_mfma_f32_16x16x32_bf16 v[52:55], v[152:155], v[24:27], v[52:55]
    v_mfma_f32_16x16x32_bf16 v[52:55], v[156:159], v[28:31], v[52:55]
    s_waitcnt vmcnt(20)
    v_mfma_f32_16x16x32_bf16 v[56:59], v[160:163], v[16:19], 0
    v_mfma_f32_16x16x32_bf16 v[56:59], v[164:167], v[20:23], v[56:59]
    v_mfma_f32_16x16x32_bf16 v[56:59], v[168:171], v[24:27], v[56:59]
    v_mfma_f32_16x16x32_bf16 v[56:59], v[172:175], v[28:31], v[56:59]
    s_waitcnt vmcnt(16)
    v_mfma_f32_16x16x32_bf16 v[60:63], v[176:179], v[16:19], 0
    v_mfma_f32_16x16x32_bf16 v[60:63], v[180:183], v[20:23], v[60:63]
    v_mfma_f32_16x16x32_bf16 v[60:63], v[184:187], v[24:27], v[60:63]
    v_mfma_f32_16x16x32_bf16 v[60:63], v[188:191], v[28:31], v[60:63]
    s_nop 7
    s_nop 1
    v_max_f32 v5, v32, v33
    v_max_f32 v5, v5, v34
    v_max_f32 v5, v5, v35
    v_max_f32 v5, v5, v36
    v_max_f32 v5, v5, v37
    v_max_f32 v5, v5, v38
    v_max_f32 v5, v5, v39
    v_max_f32 v5, v5, v40
    v_max_f32 v5, v5, v41
    v_max_f32 v5, v5, v42
    v_max_f32 v5, v5, v43
    v_max_f32 v5, v5, v44
    v_max_f32 v5, v5, v45
    v_max_f32 v5, v5, v46
    v_max_f32 v5, v5, v47
    v_max_f32 v5, v5, v48
    v_max_f32 v5, v5, v49
    v_max_f32 v5, v5, v50
    v_max_f32 v5, v5, v51
    v_max_f32 v5, v5, v52
    v_max_f32 v5, v5, v53
    v_max_f32 v5, v5, v54
    v_max_f32 v5, v5, v55
    v_max_f32 v5, v5, v56
    v_max_f32 v5, v5, v57
    v_max_f32 v5, v5, v58
    v_max_f32 v5, v5, v59
    v_max_f32 v5, v5, v60
    v_max_f32 v5, v5, v61
    v_max_f32 v5, v5, v62
    v_max_f32 v5, v5, v63
    v_lshlrev_b32 v6, 2, v2
    v_xor_b32 v9, 64, v6
    ds_bpermute_b32 v10, v9, v5
    s_waitcnt lgkmcnt(0)
    v_max_f32 v5, v5, v10
    v_xor_b32 v9, 128, v6
    ds_bpermute_b32 v10, v9, v5
    s_waitcnt lgkmcnt(0)
    v_max_f32 v5, v5, v10
    v_lshlrev_b32 v9, 2, v4
    s_lshl_b32 s31, s3, 6
    v_add_u32 v9, s31, v9
    v_add_u32 v10, 0x20000, v9
    ds_write_b32 v10, v5
    s_waitcnt lgkmcnt(0)
    s_barrier
    v_lshlrev_b32 v9, 2, v4
    v_add_u32 v9, 0x20000, v9
    ds_read_b32 v10, v9 offset:0
    ds_read_b32 v11, v9 offset:64
    ds_read_b32 v12, v9 offset:128
    ds_read_b32 v13, v9 offset:192
    ds_read_b32 v14, v9 offset:256
    ds_read_b32 v15, v9 offset:320
    ds_read_b32 v16, v9 offset:384
    ds_read_b32 v17, v9 offset:448
    s_waitcnt lgkmcnt(0)
    v_max_f32 v5, v10, v11
    v_max_f32 v5, v5, v12
    v_max_f32 v5, v5, v13
    v_max_f32 v5, v5, v14
    v_max_f32 v5, v5, v15
    v_max_f32 v5, v5, v16
    v_max_f32 v5, v5, v17
    s_mov_b32 s32, 0x3e0293ee
    v_mul_f32 v6, s32, v5
    v_sub_f32 v6, 0, v6
    v_mov_b32 v1, 0
    v_fma_f32 v32, v32, s32, v6
    v_fma_f32 v33, v33, s32, v6
    v_fma_f32 v34, v34, s32, v6
    v_fma_f32 v35, v35, s32, v6
    v_fma_f32 v36, v36, s32, v6
    v_fma_f32 v37, v37, s32, v6
    v_fma_f32 v38, v38, s32, v6
    v_fma_f32 v39, v39, s32, v6
    v_fma_f32 v40, v40, s32, v6
    v_fma_f32 v41, v41, s32, v6
    v_fma_f32 v42, v42, s32, v6
    v_fma_f32 v43, v43, s32, v6
    v_fma_f32 v44, v44, s32, v6
    v_fma_f32 v45, v45, s32, v6
    v_fma_f32 v46, v46, s32, v6
    v_fma_f32 v47, v47, s32, v6
    v_fma_f32 v48, v48, s32, v6
    v_fma_f32 v49, v49, s32, v6
    v_fma_f32 v50, v50, s32, v6
    v_fma_f32 v51, v51, s32, v6
    v_fma_f32 v52, v52, s32, v6
    v_fma_f32 v53, v53, s32, v6
    v_fma_f32 v54, v54, s32, v6
    v_fma_f32 v55, v55, s32, v6
    v_fma_f32 v56, v56, s32, v6
    v_fma_f32 v57, v57, s32, v6
    v_fma_f32 v58, v58, s32, v6
    v_fma_f32 v59, v59, s32, v6
    v_fma_f32 v60, v60, s32, v6
    v_fma_f32 v61, v61, s32, v6
    v_fma_f32 v62, v62, s32, v6
    v_fma_f32 v63, v63, s32, v6
    v_exp_f32 v32, v32
    v_exp_f32 v33, v33
    v_exp_f32 v34, v34
    v_exp_f32 v35, v35
    v_exp_f32 v36, v36
    v_exp_f32 v37, v37
    v_exp_f32 v38, v38
    v_exp_f32 v39, v39
    v_exp_f32 v40, v40
    v_exp_f32 v41, v41
    v_exp_f32 v42, v42
    v_exp_f32 v43, v43
    v_exp_f32 v44, v44
    v_exp_f32 v45, v45
    v_exp_f32 v46, v46
    v_exp_f32 v47, v47
    v_exp_f32 v48, v48
    v_exp_f32 v49, v49
    v_exp_f32 v50, v50
    v_exp_f32 v51, v51
    v_exp_f32 v52, v52
    v_exp_f32 v53, v53
    v_exp_f32 v54, v54
    v_exp_f32 v55, v55
    v_exp_f32 v56, v56
    v_exp_f32 v57, v57
    v_exp_f32 v58, v58
    v_exp_f32 v59, v59
    v_exp_f32 v60, v60
    v_exp_f32 v61, v61
    v_exp_f32 v62, v62
    v_exp_f32 v63, v63
    s_nop 0
    v_add_f32 v1, v1, v32
    v_add_f32 v1, v1, v33
    v_add_f32 v1, v1, v34
    v_add_f32 v1, v1, v35
    v_add_f32 v1, v1, v36
    v_add_f32 v1, v1, v37
    v_add_f32 v1, v1, v38
    v_add_f32 v1, v1, v39
    v_add_f32 v1, v1, v40
    v_add_f32 v1, v1, v41
    v_add_f32 v1, v1, v42
    v_add_f32 v1, v1, v43
    v_add_f32 v1, v1, v44
    v_add_f32 v1, v1, v45
    v_add_f32 v1, v1, v46
    v_add_f32 v1, v1, v47
    v_add_f32 v1, v1, v48
    v_add_f32 v1, v1, v49
    v_add_f32 v1, v1, v50
    v_add_f32 v1, v1, v51
    v_add_f32 v1, v1, v52
    v_add_f32 v1, v1, v53
    v_add_f32 v1, v1, v54
    v_add_f32 v1, v1, v55
    v_add_f32 v1, v1, v56
    v_add_f32 v1, v1, v57
    v_add_f32 v1, v1, v58
    v_add_f32 v1, v1, v59
    v_add_f32 v1, v1, v60
    v_add_f32 v1, v1, v61
    v_add_f32 v1, v1, v62
    v_add_f32 v1, v1, v63
    v_cvt_pk_bf16_f32 v16, v32, v33
    v_cvt_pk_bf16_f32 v17, v34, v35
    v_cvt_pk_bf16_f32 v18, v36, v37
    v_cvt_pk_bf16_f32 v19, v38, v39
    v_cvt_pk_bf16_f32 v20, v40, v41
    v_cvt_pk_bf16_f32 v21, v42, v43
    v_cvt_pk_bf16_f32 v22, v44, v45
    v_cvt_pk_bf16_f32 v23, v46, v47
    v_cvt_pk_bf16_f32 v24, v48, v49
    v_cvt_pk_bf16_f32 v25, v50, v51
    v_cvt_pk_bf16_f32 v26, v52, v53
    v_cvt_pk_bf16_f32 v27, v54, v55
    v_cvt_pk_bf16_f32 v28, v56, v57
    v_cvt_pk_bf16_f32 v29, v58, v59
    v_cvt_pk_bf16_f32 v30, v60, v61
    v_cvt_pk_bf16_f32 v31, v62, v63
    s_waitcnt vmcnt(8)
    ds_read_b64_tr_b16 v[64:65], v200 offset:0
    ds_read_b64_tr_b16 v[66:67], v200 offset:4096
    ds_read_b64_tr_b16 v[68:69], v201 offset:0
    ds_read_b64_tr_b16 v[70:71], v201 offset:4096
    ds_read_b64_tr_b16 v[72:73], v202 offset:0
    ds_read_b64_tr_b16 v[74:75], v202 offset:4096
    ds_read_b64_tr_b16 v[76:77], v203 offset:0
    ds_read_b64_tr_b16 v[78:79], v203 offset:4096
    ds_read_b64_tr_b16 v[80:81], v204 offset:0
    ds_read_b64_tr_b16 v[82:83], v204 offset:4096
    ds_read_b64_tr_b16 v[84:85], v205 offset:0
    ds_read_b64_tr_b16 v[86:87], v205 offset:4096
    ds_read_b64_tr_b16 v[88:89], v206 offset:0
    ds_read_b64_tr_b16 v[90:91], v206 offset:4096
    ds_read_b64_tr_b16 v[92:93], v207 offset:0
    ds_read_b64_tr_b16 v[94:95], v207 offset:4096
    s_waitcnt lgkmcnt(0)
    s_add_u32 s29, s28, 0
    s_mov_b32 m0, s29
    s_mov_b32 s30, 16384
    buffer_load_dwordx4 v7, s[20:23], s30 offen offset:0 nt lds
    buffer_load_dwordx4 v8, s[20:23], s30 offen offset:1024 nt lds
    buffer_load_dwordx4 v7, s[20:23], s30 offen offset:2048 nt lds
    buffer_load_dwordx4 v8, s[20:23], s30 offen offset:3072 nt lds
    s_add_u32 s29, s28, 4096
    s_mov_b32 m0, s29
    s_mov_b32 s30, 20480
    buffer_load_dwordx4 v7, s[20:23], s30 offen offset:0 nt lds
    buffer_load_dwordx4 v8, s[20:23], s30 offen offset:1024 nt lds
    buffer_load_dwordx4 v7, s[20:23], s30 offen offset:2048 nt lds
    buffer_load_dwordx4 v8, s[20:23], s30 offen offset:3072 nt lds
    v_mfma_f32_16x16x32_bf16 v[224:227], v[16:19], v[64:67], v[224:227]
    v_mfma_f32_16x16x32_bf16 v[228:231], v[16:19], v[68:71], v[228:231]
    v_mfma_f32_16x16x32_bf16 v[232:235], v[16:19], v[72:75], v[232:235]
    v_mfma_f32_16x16x32_bf16 v[236:239], v[16:19], v[76:79], v[236:239]
    v_mfma_f32_16x16x32_bf16 v[240:243], v[16:19], v[80:83], v[240:243]
    v_mfma_f32_16x16x32_bf16 v[244:247], v[16:19], v[84:87], v[244:247]
    v_mfma_f32_16x16x32_bf16 v[248:251], v[16:19], v[88:91], v[248:251]
    v_mfma_f32_16x16x32_bf16 v[252:255], v[16:19], v[92:95], v[252:255]
    s_waitcnt vmcnt(0)
    ds_read_b64_tr_b16 v[64:65], v200 offset:8192
    ds_read_b64_tr_b16 v[66:67], v200 offset:12288
    ds_read_b64_tr_b16 v[68:69], v201 offset:8192
    ds_read_b64_tr_b16 v[70:71], v201 offset:12288
    ds_read_b64_tr_b16 v[72:73], v202 offset:8192
    ds_read_b64_tr_b16 v[74:75], v202 offset:12288
    ds_read_b64_tr_b16 v[76:77], v203 offset:8192
    ds_read_b64_tr_b16 v[78:79], v203 offset:12288
    ds_read_b64_tr_b16 v[80:81], v204 offset:8192
    ds_read_b64_tr_b16 v[82:83], v204 offset:12288
    ds_read_b64_tr_b16 v[84:85], v205 offset:8192
    ds_read_b64_tr_b16 v[86:87], v205 offset:12288
    ds_read_b64_tr_b16 v[88:89], v206 offset:8192
    ds_read_b64_tr_b16 v[90:91], v206 offset:12288
    ds_read_b64_tr_b16 v[92:93], v207 offset:8192
    ds_read_b64_tr_b16 v[94:95], v207 offset:12288
    s_waitcnt lgkmcnt(0)
    s_add_u32 s29, s28, 8192
    s_mov_b32 m0, s29
    s_mov_b32 s30, 24576
    buffer_load_dwordx4 v7, s[20:23], s30 offen offset:0 nt lds
    buffer_load_dwordx4 v8, s[20:23], s30 offen offset:1024 nt lds
    buffer_load_dwordx4 v7, s[20:23], s30 offen offset:2048 nt lds
    buffer_load_dwordx4 v8, s[20:23], s30 offen offset:3072 nt lds
    s_add_u32 s29, s28, 12288
    s_mov_b32 m0, s29
    s_mov_b32 s30, 28672
    buffer_load_dwordx4 v7, s[20:23], s30 offen offset:0 nt lds
    buffer_load_dwordx4 v8, s[20:23], s30 offen offset:1024 nt lds
    buffer_load_dwordx4 v7, s[20:23], s30 offen offset:2048 nt lds
    buffer_load_dwordx4 v8, s[20:23], s30 offen offset:3072 nt lds
    v_mfma_f32_16x16x32_bf16 v[224:227], v[20:23], v[64:67], v[224:227]
    v_mfma_f32_16x16x32_bf16 v[228:231], v[20:23], v[68:71], v[228:231]
    v_mfma_f32_16x16x32_bf16 v[232:235], v[20:23], v[72:75], v[232:235]
    v_mfma_f32_16x16x32_bf16 v[236:239], v[20:23], v[76:79], v[236:239]
    v_mfma_f32_16x16x32_bf16 v[240:243], v[20:23], v[80:83], v[240:243]
    v_mfma_f32_16x16x32_bf16 v[244:247], v[20:23], v[84:87], v[244:247]
    v_mfma_f32_16x16x32_bf16 v[248:251], v[20:23], v[88:91], v[248:251]
    v_mfma_f32_16x16x32_bf16 v[252:255], v[20:23], v[92:95], v[252:255]
    s_waitcnt vmcnt(8)
    ds_read_b64_tr_b16 v[64:65], v200 offset:0
    ds_read_b64_tr_b16 v[66:67], v200 offset:4096
    ds_read_b64_tr_b16 v[68:69], v201 offset:0
    ds_read_b64_tr_b16 v[70:71], v201 offset:4096
    ds_read_b64_tr_b16 v[72:73], v202 offset:0
    ds_read_b64_tr_b16 v[74:75], v202 offset:4096
    ds_read_b64_tr_b16 v[76:77], v203 offset:0
    ds_read_b64_tr_b16 v[78:79], v203 offset:4096
    ds_read_b64_tr_b16 v[80:81], v204 offset:0
    ds_read_b64_tr_b16 v[82:83], v204 offset:4096
    ds_read_b64_tr_b16 v[84:85], v205 offset:0
    ds_read_b64_tr_b16 v[86:87], v205 offset:4096
    ds_read_b64_tr_b16 v[88:89], v206 offset:0
    ds_read_b64_tr_b16 v[90:91], v206 offset:4096
    ds_read_b64_tr_b16 v[92:93], v207 offset:0
    ds_read_b64_tr_b16 v[94:95], v207 offset:4096
    s_waitcnt lgkmcnt(0)
    v_mfma_f32_16x16x32_bf16 v[224:227], v[24:27], v[64:67], v[224:227]
    v_mfma_f32_16x16x32_bf16 v[228:231], v[24:27], v[68:71], v[228:231]
    v_mfma_f32_16x16x32_bf16 v[232:235], v[24:27], v[72:75], v[232:235]
    v_mfma_f32_16x16x32_bf16 v[236:239], v[24:27], v[76:79], v[236:239]
    v_mfma_f32_16x16x32_bf16 v[240:243], v[24:27], v[80:83], v[240:243]
    v_mfma_f32_16x16x32_bf16 v[244:247], v[24:27], v[84:87], v[244:247]
    v_mfma_f32_16x16x32_bf16 v[248:251], v[24:27], v[88:91], v[248:251]
    v_mfma_f32_16x16x32_bf16 v[252:255], v[24:27], v[92:95], v[252:255]
    s_waitcnt vmcnt(0)
    ds_read_b64_tr_b16 v[64:65], v200 offset:8192
    ds_read_b64_tr_b16 v[66:67], v200 offset:12288
    ds_read_b64_tr_b16 v[68:69], v201 offset:8192
    ds_read_b64_tr_b16 v[70:71], v201 offset:12288
    ds_read_b64_tr_b16 v[72:73], v202 offset:8192
    ds_read_b64_tr_b16 v[74:75], v202 offset:12288
    ds_read_b64_tr_b16 v[76:77], v203 offset:8192
    ds_read_b64_tr_b16 v[78:79], v203 offset:12288
    ds_read_b64_tr_b16 v[80:81], v204 offset:8192
    ds_read_b64_tr_b16 v[82:83], v204 offset:12288
    ds_read_b64_tr_b16 v[84:85], v205 offset:8192
    ds_read_b64_tr_b16 v[86:87], v205 offset:12288
    ds_read_b64_tr_b16 v[88:89], v206 offset:8192
    ds_read_b64_tr_b16 v[90:91], v206 offset:12288
    ds_read_b64_tr_b16 v[92:93], v207 offset:8192
    ds_read_b64_tr_b16 v[94:95], v207 offset:12288
    s_waitcnt lgkmcnt(0)
    v_mfma_f32_16x16x32_bf16 v[224:227], v[28:31], v[64:67], v[224:227]
    v_mfma_f32_16x16x32_bf16 v[228:231], v[28:31], v[68:71], v[228:231]
    v_mfma_f32_16x16x32_bf16 v[232:235], v[28:31], v[72:75], v[232:235]
    v_mfma_f32_16x16x32_bf16 v[236:239], v[28:31], v[76:79], v[236:239]
    v_mfma_f32_16x16x32_bf16 v[240:243], v[28:31], v[80:83], v[240:243]
    v_mfma_f32_16x16x32_bf16 v[244:247], v[28:31], v[84:87], v[244:247]
    v_mfma_f32_16x16x32_bf16 v[248:251], v[28:31], v[88:91], v[248:251]
    v_mfma_f32_16x16x32_bf16 v[252:255], v[28:31], v[92:95], v[252:255]
    s_nop 7
    s_nop 1
    s_barrier
    s_lshl_b32 s31, s3, 8
    v_lshlrev_b32 v9, 2, v2
    v_add_u32 v9, s31, v9
    v_add_u32 v9, 0x20400, v9
    ds_write_b32 v9, v1
    s_lshl_b32 s31, s3, 11
    v_lshlrev_b32 v9, 2, v4
    v_add_u32 v9, s31, v9
    v_cmp_gt_u32 vcc, 16, v2
    s_and_saveexec_b64 s[34:35], vcc
    ds_write_b32 v9, v224 offset:0
    ds_write_b32 v9, v225 offset:512
    ds_write_b32 v9, v226 offset:1024
    ds_write_b32 v9, v227 offset:1536
    ds_write_b32 v9, v228 offset:64
    ds_write_b32 v9, v229 offset:576
    ds_write_b32 v9, v230 offset:1088
    ds_write_b32 v9, v231 offset:1600
    ds_write_b32 v9, v232 offset:128
    ds_write_b32 v9, v233 offset:640
    ds_write_b32 v9, v234 offset:1152
    ds_write_b32 v9, v235 offset:1664
    ds_write_b32 v9, v236 offset:192
    ds_write_b32 v9, v237 offset:704
    ds_write_b32 v9, v238 offset:1216
    ds_write_b32 v9, v239 offset:1728
    ds_write_b32 v9, v240 offset:256
    ds_write_b32 v9, v241 offset:768
    ds_write_b32 v9, v242 offset:1280
    ds_write_b32 v9, v243 offset:1792
    ds_write_b32 v9, v244 offset:320
    ds_write_b32 v9, v245 offset:832
    ds_write_b32 v9, v246 offset:1344
    ds_write_b32 v9, v247 offset:1856
    ds_write_b32 v9, v248 offset:384
    ds_write_b32 v9, v249 offset:896
    ds_write_b32 v9, v250 offset:1408
    ds_write_b32 v9, v251 offset:1920
    ds_write_b32 v9, v252 offset:448
    ds_write_b32 v9, v253 offset:960
    ds_write_b32 v9, v254 offset:1472
    ds_write_b32 v9, v255 offset:1984
    s_mov_b64 exec, s[34:35]
    s_waitcnt lgkmcnt(0)
    s_barrier
    v_lshlrev_b32 v9, 2, v0
    ds_read_b32 v10, v9 offset:0
    ds_read_b32 v11, v9 offset:2048
    ds_read_b32 v12, v9 offset:4096
    ds_read_b32 v13, v9 offset:6144
    ds_read_b32 v14, v9 offset:8192
    ds_read_b32 v15, v9 offset:10240
    ds_read_b32 v16, v9 offset:12288
    ds_read_b32 v17, v9 offset:14336
    s_add_u32 s24, s8, 65536
    s_addc_u32 s25, s9, 0
    s_mov_b32 s26, 524288
    s_mov_b32 s27, 0x00020000
    s_add_u32 s36, s8, 589824
    s_addc_u32 s37, s9, 0
    s_mov_b32 s38, 8192
    s_mov_b32 s39, 0x00020000
    s_waitcnt lgkmcnt(0)
    v_add_f32 v10, v10, v11
    v_add_f32 v10, v10, v12
    v_add_f32 v10, v10, v13
    v_add_f32 v10, v10, v14
    v_add_f32 v10, v10, v15
    v_add_f32 v10, v10, v16
    v_add_f32 v10, v10, v17
    s_lshl_b32 s31, s2, 11
    v_add_u32 v9, s31, v9
    buffer_store_dword v10, v9, s[24:27], 0 offen
    v_cmp_gt_u32 vcc, 4, v0
    s_and_saveexec_b64 s[34:35], vcc
    s_cbranch_execz K2_END
    v_lshlrev_b32 v9, 2, v0
    v_add_u32 v9, 0x20400, v9
    ds_read_b32 v32, v9 offset:0
    ds_read_b32 v33, v9 offset:64
    ds_read_b32 v34, v9 offset:128
    ds_read_b32 v35, v9 offset:192
    ds_read_b32 v36, v9 offset:256
    ds_read_b32 v37, v9 offset:320
    ds_read_b32 v38, v9 offset:384
    ds_read_b32 v39, v9 offset:448
    ds_read_b32 v40, v9 offset:512
    ds_read_b32 v41, v9 offset:576
    ds_read_b32 v42, v9 offset:640
    ds_read_b32 v43, v9 offset:704
    ds_read_b32 v44, v9 offset:768
    ds_read_b32 v45, v9 offset:832
    ds_read_b32 v46, v9 offset:896
    ds_read_b32 v47, v9 offset:960
    ds_read_b32 v48, v9 offset:1024
    ds_read_b32 v49, v9 offset:1088
    ds_read_b32 v50, v9 offset:1152
    ds_read_b32 v51, v9 offset:1216
    ds_read_b32 v52, v9 offset:1280
    ds_read_b32 v53, v9 offset:1344
    ds_read_b32 v54, v9 offset:1408
    ds_read_b32 v55, v9 offset:1472
    ds_read_b32 v56, v9 offset:1536
    ds_read_b32 v57, v9 offset:1600
    ds_read_b32 v58, v9 offset:1664
    ds_read_b32 v59, v9 offset:1728
    ds_read_b32 v60, v9 offset:1792
    ds_read_b32 v61, v9 offset:1856
    ds_read_b32 v62, v9 offset:1920
    ds_read_b32 v63, v9 offset:1984
    s_waitcnt lgkmcnt(0)
    v_add_f32 v32, v32, v33
    v_add_f32 v32, v32, v34
    v_add_f32 v32, v32, v35
    v_add_f32 v32, v32, v36
    v_add_f32 v32, v32, v37
    v_add_f32 v32, v32, v38
    v_add_f32 v32, v32, v39
    v_add_f32 v32, v32, v40
    v_add_f32 v32, v32, v41
    v_add_f32 v32, v32, v42
    v_add_f32 v32, v32, v43
    v_add_f32 v32, v32, v44
    v_add_f32 v32, v32, v45
    v_add_f32 v32, v32, v46
    v_add_f32 v32, v32, v47
    v_add_f32 v32, v32, v48
    v_add_f32 v32, v32, v49
    v_add_f32 v32, v32, v50
    v_add_f32 v32, v32, v51
    v_add_f32 v32, v32, v52
    v_add_f32 v32, v32, v53
    v_add_f32 v32, v32, v54
    v_add_f32 v32, v32, v55
    v_add_f32 v32, v32, v56
    v_add_f32 v32, v32, v57
    v_add_f32 v32, v32, v58
    v_add_f32 v32, v32, v59
    v_add_f32 v32, v32, v60
    v_add_f32 v32, v32, v61
    v_add_f32 v32, v32, v62
    v_add_f32 v32, v32, v63
    v_mul_f32 v33, s32, v5
    v_mov_b32 v34, v32
    v_mov_b32 v32, v33
    v_mov_b32 v33, v34
    s_lshl_b32 s31, s2, 5
    v_lshlrev_b32 v9, 3, v0
    v_add_u32 v9, s31, v9
    buffer_store_dwordx2 v[32:33], v9, s[36:39], 0 offen
K2_END:
    s_endpgm
.globl comb_kernel
.p2align 8
.type comb_kernel,@function
comb_kernel:
    s_cmp_ge_u32 s2, 256
    s_cbranch_scc1 K3_END
    s_load_dwordx2 s[4:5], s[0:1], 32
    s_load_dwordx2 s[6:7], s[0:1], 64
    s_load_dwordx2 s[8:9], s[0:1], 96
    s_waitcnt lgkmcnt(0)
    s_mov_b32 s12, s4
    s_mov_b32 s13, s5
    s_mov_b32 s14, 4194304
    s_mov_b32 s15, 0x00020000
    s_mov_b32 s16, s6
    s_mov_b32 s17, s7
    s_mov_b32 s18, 1835008
    s_mov_b32 s19, 0x00020000
    s_mov_b32 s20, s8
    s_mov_b32 s21, s9
    s_mov_b32 s22, 2097152
    s_mov_b32 s23, 0x00020000
    s_lshl_b32 s24, s2, 14
    v_lshlrev_b32 v1, 2, v0
    v_add_u32 v2, s24, v1
    v_add_u32 v3, 0, v2
    buffer_load_dword v16, v3, s[12:15], 0 offen offset:0
    buffer_load_dword v17, v3, s[12:15], 0 offen offset:1024
    buffer_load_dword v18, v3, s[12:15], 0 offen offset:2048
    buffer_load_dword v19, v3, s[12:15], 0 offen offset:3072
    v_add_u32 v3, 4096, v2
    buffer_load_dword v20, v3, s[12:15], 0 offen offset:0
    buffer_load_dword v21, v3, s[12:15], 0 offen offset:1024
    buffer_load_dword v22, v3, s[12:15], 0 offen offset:2048
    buffer_load_dword v23, v3, s[12:15], 0 offen offset:3072
    v_add_u32 v3, 8192, v2
    buffer_load_dword v24, v3, s[12:15], 0 offen offset:0
    buffer_load_dword v25, v3, s[12:15], 0 offen offset:1024
    buffer_load_dword v26, v3, s[12:15], 0 offen offset:2048
    buffer_load_dword v27, v3, s[12:15], 0 offen offset:3072
    v_add_u32 v3, 12288, v2
    buffer_load_dword v28, v3, s[12:15], 0 offen offset:0
    buffer_load_dword v29, v3, s[12:15], 0 offen offset:1024
    buffer_load_dword v30, v3, s[12:15], 0 offen offset:2048
    buffer_load_dword v31, v3, s[12:15], 0 offen offset:3072
    s_mul_i32 s25, s2, 7168
    v_add_u32 v2, s25, v1
    v_add_u32 v3, 0, v2
    buffer_load_dword v32, v3, s[16:19], 0 offen offset:0
    buffer_load_dword v33, v3, s[16:19], 0 offen offset:1024
    buffer_load_dword v34, v3, s[16:19], 0 offen offset:2048
    buffer_load_dword v35, v3, s[16:19], 0 offen offset:3072
    v_add_u32 v3, 4096, v2
    buffer_load_dword v36, v3, s[16:19], 0 offen offset:0
    buffer_load_dword v37, v3, s[16:19], 0 offen offset:1024
    buffer_load_dword v38, v3, s[16:19], 0 offen offset:2048
    s_lshr_b32 s26, s2, 3
    s_lshr_b32 s27, s26, 2
    s_and_b32 s28, s26, 3
    s_lshl_b32 s29, s27, 10
    s_lshl_b32 s30, s28, 3
    s_add_u32 s29, s29, s30
    s_add_u32 s29, s29, 589824
    v_mov_b32 v4, s29
    buffer_load_dwordx2 v[64:65], v4, s[20:23], 0 offen offset:0
    buffer_load_dwordx2 v[66:67], v4, s[20:23], 0 offen offset:32
    buffer_load_dwordx2 v[68:69], v4, s[20:23], 0 offen offset:64
    buffer_load_dwordx2 v[70:71], v4, s[20:23], 0 offen offset:96
    buffer_load_dwordx2 v[72:73], v4, s[20:23], 0 offen offset:128
    buffer_load_dwordx2 v[74:75], v4, s[20:23], 0 offen offset:160
    buffer_load_dwordx2 v[76:77], v4, s[20:23], 0 offen offset:192
    buffer_load_dwordx2 v[78:79], v4, s[20:23], 0 offen offset:224
    buffer_load_dwordx2 v[80:81], v4, s[20:23], 0 offen offset:256
    buffer_load_dwordx2 v[82:83], v4, s[20:23], 0 offen offset:288
    buffer_load_dwordx2 v[84:85], v4, s[20:23], 0 offen offset:320
    buffer_load_dwordx2 v[86:87], v4, s[20:23], 0 offen offset:352
    buffer_load_dwordx2 v[88:89], v4, s[20:23], 0 offen offset:384
    buffer_load_dwordx2 v[90:91], v4, s[20:23], 0 offen offset:416
    buffer_load_dwordx2 v[92:93], v4, s[20:23], 0 offen offset:448
    buffer_load_dwordx2 v[94:95], v4, s[20:23], 0 offen offset:480
    buffer_load_dwordx2 v[96:97], v4, s[20:23], 0 offen offset:512
    buffer_load_dwordx2 v[98:99], v4, s[20:23], 0 offen offset:544
    buffer_load_dwordx2 v[100:101], v4, s[20:23], 0 offen offset:576
    buffer_load_dwordx2 v[102:103], v4, s[20:23], 0 offen offset:608
    buffer_load_dwordx2 v[104:105], v4, s[20:23], 0 offen offset:640
    buffer_load_dwordx2 v[106:107], v4, s[20:23], 0 offen offset:672
    buffer_load_dwordx2 v[108:109], v4, s[20:23], 0 offen offset:704
    buffer_load_dwordx2 v[110:111], v4, s[20:23], 0 offen offset:736
    buffer_load_dwordx2 v[112:113], v4, s[20:23], 0 offen offset:768
    buffer_load_dwordx2 v[114:115], v4, s[20:23], 0 offen offset:800
    buffer_load_dwordx2 v[116:117], v4, s[20:23], 0 offen offset:832
    buffer_load_dwordx2 v[118:119], v4, s[20:23], 0 offen offset:864
    buffer_load_dwordx2 v[120:121], v4, s[20:23], 0 offen offset:896
    buffer_load_dwordx2 v[122:123], v4, s[20:23], 0 offen offset:928
    buffer_load_dwordx2 v[124:125], v4, s[20:23], 0 offen offset:960
    buffer_load_dwordx2 v[126:127], v4, s[20:23], 0 offen offset:992
    v_lshrrev_b32 v5, 3, v0
    v_and_b32 v6, 7, v0
    s_lshl_b32 s30, s27, 16
    s_lshl_b32 s31, s28, 9
    s_add_u32 s30, s30, s31
    s_and_b32 s31, s2, 7
    s_lshl_b32 s31, s31, 6
    s_add_u32 s30, s30, s31
    s_add_u32 s30, s30, 65536
    v_lshlrev_b32 v7, 11, v5
    v_lshl_add_u32 v7, v6, 3, v7
    v_add_u32 v7, s30, v7
    buffer_load_dwordx2 v[8:9], v7, s[20:23], 0 offen
    s_mul_i32 s30, s2, 28
    s_add_u32 s30, s30, 16384
    v_mov_b32 v7, s30
    buffer_load_dword v40, v7, s[20:23], 0 offen offset:0
    buffer_load_dword v41, v7, s[20:23], 0 offen offset:4
    buffer_load_dword v42, v7, s[20:23], 0 offen offset:8
    buffer_load_dword v43, v7, s[20:23], 0 offen offset:12
    buffer_load_dword v44, v7, s[20:23], 0 offen offset:16
    buffer_load_dword v45, v7, s[20:23], 0 offen offset:20
    buffer_load_dword v46, v7, s[20:23], 0 offen offset:24
    s_waitcnt vmcnt(8)
    v_max_f32 v10, v64, v66
    v_max_f32 v10, v10, v68
    v_max_f32 v10, v10, v70
    v_max_f32 v10, v10, v72
    v_max_f32 v10, v10, v74
    v_max_f32 v10, v10, v76
    v_max_f32 v10, v10, v78
    v_max_f32 v10, v10, v80
    v_max_f32 v10, v10, v82
    v_max_f32 v10, v10, v84
    v_max_f32 v10, v10, v86
    v_max_f32 v10, v10, v88
    v_max_f32 v10, v10, v90
    v_max_f32 v10, v10, v92
    v_max_f32 v10, v10, v94
    v_max_f32 v10, v10, v96
    v_max_f32 v10, v10, v98
    v_max_f32 v10, v10, v100
    v_max_f32 v10, v10, v102
    v_max_f32 v10, v10, v104
    v_max_f32 v10, v10, v106
    v_max_f32 v10, v10, v108
    v_max_f32 v10, v10, v110
    v_max_f32 v10, v10, v112
    v_max_f32 v10, v10, v114
    v_max_f32 v10, v10, v116
    v_max_f32 v10, v10, v118
    v_max_f32 v10, v10, v120
    v_max_f32 v10, v10, v122
    v_max_f32 v10, v10, v124
    v_max_f32 v10, v10, v126
    v_mov_b32 v11, 0
    v_sub_f32 v64, v64, v10
    v_exp_f32 v64, v64
    v_sub_f32 v66, v66, v10
    v_exp_f32 v66, v66
    v_sub_f32 v68, v68, v10
    v_exp_f32 v68, v68
    v_sub_f32 v70, v70, v10
    v_exp_f32 v70, v70
    v_sub_f32 v72, v72, v10
    v_exp_f32 v72, v72
    v_sub_f32 v74, v74, v10
    v_exp_f32 v74, v74
    v_sub_f32 v76, v76, v10
    v_exp_f32 v76, v76
    v_sub_f32 v78, v78, v10
    v_exp_f32 v78, v78
    v_sub_f32 v80, v80, v10
    v_exp_f32 v80, v80
    v_sub_f32 v82, v82, v10
    v_exp_f32 v82, v82
    v_sub_f32 v84, v84, v10
    v_exp_f32 v84, v84
    v_sub_f32 v86, v86, v10
    v_exp_f32 v86, v86
    v_sub_f32 v88, v88, v10
    v_exp_f32 v88, v88
    v_sub_f32 v90, v90, v10
    v_exp_f32 v90, v90
    v_sub_f32 v92, v92, v10
    v_exp_f32 v92, v92
    v_sub_f32 v94, v94, v10
    v_exp_f32 v94, v94
    v_sub_f32 v96, v96, v10
    v_exp_f32 v96, v96
    v_sub_f32 v98, v98, v10
    v_exp_f32 v98, v98
    v_sub_f32 v100, v100, v10
    v_exp_f32 v100, v100
    v_sub_f32 v102, v102, v10
    v_exp_f32 v102, v102
    v_sub_f32 v104, v104, v10
    v_exp_f32 v104, v104
    v_sub_f32 v106, v106, v10
    v_exp_f32 v106, v106
    v_sub_f32 v108, v108, v10
    v_exp_f32 v108, v108
    v_sub_f32 v110, v110, v10
    v_exp_f32 v110, v110
    v_sub_f32 v112, v112, v10
    v_exp_f32 v112, v112
    v_sub_f32 v114, v114, v10
    v_exp_f32 v114, v114
    v_sub_f32 v116, v116, v10
    v_exp_f32 v116, v116
    v_sub_f32 v118, v118, v10
    v_exp_f32 v118, v118
    v_sub_f32 v120, v120, v10
    v_exp_f32 v120, v120
    v_sub_f32 v122, v122, v10
    v_exp_f32 v122, v122
    v_sub_f32 v124, v124, v10
    v_exp_f32 v124, v124
    v_sub_f32 v126, v126, v10
    v_exp_f32 v126, v126
    s_nop 0
    v_fmac_f32 v11, v64, v65
    v_fmac_f32 v11, v66, v67
    v_fmac_f32 v11, v68, v69
    v_fmac_f32 v11, v70, v71
    v_fmac_f32 v11, v72, v73
    v_fmac_f32 v11, v74, v75
    v_fmac_f32 v11, v76, v77
    v_fmac_f32 v11, v78, v79
    v_fmac_f32 v11, v80, v81
    v_fmac_f32 v11, v82, v83
    v_fmac_f32 v11, v84, v85
    v_fmac_f32 v11, v86, v87
    v_fmac_f32 v11, v88, v89
    v_fmac_f32 v11, v90, v91
    v_fmac_f32 v11, v92, v93
    v_fmac_f32 v11, v94, v95
    v_fmac_f32 v11, v96, v97
    v_fmac_f32 v11, v98, v99
    v_fmac_f32 v11, v100, v101
    v_fmac_f32 v11, v102, v103
    v_fmac_f32 v11, v104, v105
    v_fmac_f32 v11, v106, v107
    v_fmac_f32 v11, v108, v109
    v_fmac_f32 v11, v110, v111
    v_fmac_f32 v11, v112, v113
    v_fmac_f32 v11, v114, v115
    v_fmac_f32 v11, v116, v117
    v_fmac_f32 v11, v118, v119
    v_fmac_f32 v11, v120, v121
    v_fmac_f32 v11, v122, v123
    v_fmac_f32 v11, v124, v125
    v_fmac_f32 v11, v126, v127
    v_rcp_f32 v11, v11
    v_lshlrev_b32 v12, 2, v5
    v_cmp_eq_u32 vcc, 0, v0
    s_and_saveexec_b64 s[34:35], vcc
    v_mov_b32 v13, 0
    ds_write_b32 v13, v64 offset:0
    ds_write_b32 v13, v66 offset:4
    ds_write_b32 v13, v68 offset:8
    ds_write_b32 v13, v70 offset:12
    ds_write_b32 v13, v72 offset:16
    ds_write_b32 v13, v74 offset:20
    ds_write_b32 v13, v76 offset:24
    ds_write_b32 v13, v78 offset:28
    ds_write_b32 v13, v80 offset:32
    ds_write_b32 v13, v82 offset:36
    ds_write_b32 v13, v84 offset:40
    ds_write_b32 v13, v86 offset:44
    ds_write_b32 v13, v88 offset:48
    ds_write_b32 v13, v90 offset:52
    ds_write_b32 v13, v92 offset:56
    ds_write_b32 v13, v94 offset:60
    ds_write_b32 v13, v96 offset:64
    ds_write_b32 v13, v98 offset:68
    ds_write_b32 v13, v100 offset:72
    ds_write_b32 v13, v102 offset:76
    ds_write_b32 v13, v104 offset:80
    ds_write_b32 v13, v106 offset:84
    ds_write_b32 v13, v108 offset:88
    ds_write_b32 v13, v110 offset:92
    ds_write_b32 v13, v112 offset:96
    ds_write_b32 v13, v114 offset:100
    ds_write_b32 v13, v116 offset:104
    ds_write_b32 v13, v118 offset:108
    ds_write_b32 v13, v120 offset:112
    ds_write_b32 v13, v122 offset:116
    ds_write_b32 v13, v124 offset:120
    ds_write_b32 v13, v126 offset:124
    s_mov_b64 exec, s[34:35]
    s_waitcnt lgkmcnt(0)
    s_barrier
    ds_read_b32 v13, v12
    s_waitcnt vmcnt(7) lgkmcnt(0)
    v_mul_f32 v13, v13, v11
    v_mul_f32 v8, v8, v13
    v_mul_f32 v9, v9, v13
    v_lshlrev_b32 v12, 3, v0
    ds_write_b64 v12, v[8:9] offset:256
    s_waitcnt lgkmcnt(0)
    s_barrier
    v_and_b32 v12, 15, v0
    v_lshlrev_b32 v12, 2, v12
    ds_read_b32 v64, v12 offset:256
    ds_read_b32 v65, v12 offset:320
    ds_read_b32 v66, v12 offset:384
    ds_read_b32 v67, v12 offset:448
    ds_read_b32 v68, v12 offset:512
    ds_read_b32 v69, v12 offset:576
    ds_read_b32 v70, v12 offset:640
    ds_read_b32 v71, v12 offset:704
    ds_read_b32 v72, v12 offset:768
    ds_read_b32 v73, v12 offset:832
    ds_read_b32 v74, v12 offset:896
    ds_read_b32 v75, v12 offset:960
    ds_read_b32 v76, v12 offset:1024
    ds_read_b32 v77, v12 offset:1088
    ds_read_b32 v78, v12 offset:1152
    ds_read_b32 v79, v12 offset:1216
    ds_read_b32 v80, v12 offset:1280
    ds_read_b32 v81, v12 offset:1344
    ds_read_b32 v82, v12 offset:1408
    ds_read_b32 v83, v12 offset:1472
    ds_read_b32 v84, v12 offset:1536
    ds_read_b32 v85, v12 offset:1600
    ds_read_b32 v86, v12 offset:1664
    ds_read_b32 v87, v12 offset:1728
    ds_read_b32 v88, v12 offset:1792
    ds_read_b32 v89, v12 offset:1856
    ds_read_b32 v90, v12 offset:1920
    ds_read_b32 v91, v12 offset:1984
    ds_read_b32 v92, v12 offset:2048
    ds_read_b32 v93, v12 offset:2112
    ds_read_b32 v94, v12 offset:2176
    ds_read_b32 v95, v12 offset:2240
    s_waitcnt lgkmcnt(0)
    v_add_f32 v64, v64, v65
    v_add_f32 v64, v64, v66
    v_add_f32 v64, v64, v67
    v_add_f32 v64, v64, v68
    v_add_f32 v64, v64, v69
    v_add_f32 v64, v64, v70
    v_add_f32 v64, v64, v71
    v_add_f32 v64, v64, v72
    v_add_f32 v64, v64, v73
    v_add_f32 v64, v64, v74
    v_add_f32 v64, v64, v75
    v_add_f32 v64, v64, v76
    v_add_f32 v64, v64, v77
    v_add_f32 v64, v64, v78
    v_add_f32 v64, v64, v79
    v_add_f32 v64, v64, v80
    v_add_f32 v64, v64, v81
    v_add_f32 v64, v64, v82
    v_add_f32 v64, v64, v83
    v_add_f32 v64, v64, v84
    v_add_f32 v64, v64, v85
    v_add_f32 v64, v64, v86
    v_add_f32 v64, v64, v87
    v_add_f32 v64, v64, v88
    v_add_f32 v64, v64, v89
    v_add_f32 v64, v64, v90
    v_add_f32 v64, v64, v91
    v_add_f32 v64, v64, v92
    v_add_f32 v64, v64, v93
    v_add_f32 v64, v64, v94
    v_add_f32 v64, v64, v95
    s_barrier
    ds_write_b32 v12, v64 offset:4096
    s_waitcnt lgkmcnt(0)
    s_barrier
    v_mov_b32 v12, 0
    ds_read_b128 v[64:67], v12 offset:4096
    ds_read_b128 v[68:71], v12 offset:4112
    ds_read_b128 v[72:75], v12 offset:4128
    ds_read_b128 v[76:79], v12 offset:4144
    s_waitcnt vmcnt(0) lgkmcnt(0)
    v_mov_b32 v8, 0
    v_mov_b32 v9, 0
    v_mov_b32 v10, 0
    v_mov_b32 v11, 0
    v_lshlrev_b32 v12, 16, v16
    v_and_b32 v13, 0xffff0000, v16
    v_fmac_f32 v8, v64, v12
    v_fmac_f32 v9, v64, v13
    v_lshlrev_b32 v12, 16, v17
    v_and_b32 v13, 0xffff0000, v17
    v_fmac_f32 v8, v65, v12
    v_fmac_f32 v9, v65, v13
    v_lshlrev_b32 v12, 16, v18
    v_and_b32 v13, 0xffff0000, v18
    v_fmac_f32 v8, v66, v12
    v_fmac_f32 v9, v66, v13
    v_lshlrev_b32 v12, 16, v19
    v_and_b32 v13, 0xffff0000, v19
    v_fmac_f32 v8, v67, v12
    v_fmac_f32 v9, v67, v13
    v_lshlrev_b32 v12, 16, v20
    v_and_b32 v13, 0xffff0000, v20
    v_fmac_f32 v8, v68, v12
    v_fmac_f32 v9, v68, v13
    v_lshlrev_b32 v12, 16, v21
    v_and_b32 v13, 0xffff0000, v21
    v_fmac_f32 v8, v69, v12
    v_fmac_f32 v9, v69, v13
    v_lshlrev_b32 v12, 16, v22
    v_and_b32 v13, 0xffff0000, v22
    v_fmac_f32 v8, v70, v12
    v_fmac_f32 v9, v70, v13
    v_lshlrev_b32 v12, 16, v23
    v_and_b32 v13, 0xffff0000, v23
    v_fmac_f32 v8, v71, v12
    v_fmac_f32 v9, v71, v13
    v_lshlrev_b32 v12, 16, v24
    v_and_b32 v13, 0xffff0000, v24
    v_fmac_f32 v8, v72, v12
    v_fmac_f32 v9, v72, v13
    v_lshlrev_b32 v12, 16, v25
    v_and_b32 v13, 0xffff0000, v25
    v_fmac_f32 v8, v73, v12
    v_fmac_f32 v9, v73, v13
    v_lshlrev_b32 v12, 16, v26
    v_and_b32 v13, 0xffff0000, v26
    v_fmac_f32 v8, v74, v12
    v_fmac_f32 v9, v74, v13
    v_lshlrev_b32 v12, 16, v27
    v_and_b32 v13, 0xffff0000, v27
    v_fmac_f32 v8, v75, v12
    v_fmac_f32 v9, v75, v13
    v_lshlrev_b32 v12, 16, v28
    v_and_b32 v13, 0xffff0000, v28
    v_fmac_f32 v8, v76, v12
    v_fmac_f32 v9, v76, v13
    v_lshlrev_b32 v12, 16, v29
    v_and_b32 v13, 0xffff0000, v29
    v_fmac_f32 v8, v77, v12
    v_fmac_f32 v9, v77, v13
    v_lshlrev_b32 v12, 16, v30
    v_and_b32 v13, 0xffff0000, v30
    v_fmac_f32 v8, v78, v12
    v_fmac_f32 v9, v78, v13
    v_lshlrev_b32 v12, 16, v31
    v_and_b32 v13, 0xffff0000, v31
    v_fmac_f32 v8, v79, v12
    v_fmac_f32 v9, v79, v13
    v_lshlrev_b32 v12, 16, v32
    v_and_b32 v13, 0xffff0000, v32
    v_fmac_f32 v10, v40, v12
    v_fmac_f32 v11, v40, v13
    v_lshlrev_b32 v12, 16, v33
    v_and_b32 v13, 0xffff0000, v33
    v_fmac_f32 v10, v41, v12
    v_fmac_f32 v11, v41, v13
    v_lshlrev_b32 v12, 16, v34
    v_and_b32 v13, 0xffff0000, v34
    v_fmac_f32 v10, v42, v12
    v_fmac_f32 v11, v42, v13
    v_lshlrev_b32 v12, 16, v35
    v_and_b32 v13, 0xffff0000, v35
    v_fmac_f32 v10, v43, v12
    v_fmac_f32 v11, v43, v13
    v_lshlrev_b32 v12, 16, v36
    v_and_b32 v13, 0xffff0000, v36
    v_fmac_f32 v10, v44, v12
    v_fmac_f32 v11, v44, v13
    v_lshlrev_b32 v12, 16, v37
    v_and_b32 v13, 0xffff0000, v37
    v_fmac_f32 v10, v45, v12
    v_fmac_f32 v11, v45, v13
    v_lshlrev_b32 v12, 16, v38
    v_and_b32 v13, 0xffff0000, v38
    v_fmac_f32 v10, v46, v12
    v_fmac_f32 v11, v46, v13
    s_lshl_b32 s30, s2, 11
    v_lshlrev_b32 v12, 3, v0
    v_add_u32 v12, s30, v12
    v_add_u32 v13, 1048576, v12
    buffer_store_dwordx2 v[8:9], v13, s[20:23], 0 offen
    v_add_u32 v13, 1572864, v12
    buffer_store_dwordx2 v[10:11], v13, s[20:23], 0 offen
K3_END:
    s_endpgm
.globl final_kernel
.p2align 8
.type final_kernel,@function
final_kernel:
    s_cmp_ge_u32 s2, 8
    s_cbranch_scc1 K4_END
    s_load_dwordx2 s[4:5], s[0:1], 0
    s_load_dwordx2 s[6:7], s[0:1], 72
    s_load_dwordx2 s[8:9], s[0:1], 96
    s_load_dwordx2 s[10:11], s[0:1], 80
    s_mov_b32 s40, 0x7fff
    s_waitcnt lgkmcnt(0)
    s_mov_b32 s12, s4
    s_mov_b32 s13, s5
    s_mov_b32 s14, 1024
    s_mov_b32 s15, 0x00020000
    s_mov_b32 s16, s6
    s_mov_b32 s17, s7
    s_mov_b32 s18, 1024
    s_mov_b32 s19, 0x00020000
    s_mov_b32 s20, s8
    s_mov_b32 s21, s9
    s_mov_b32 s22, 2097152
    s_mov_b32 s23, 0x00020000
    s_mov_b32 s24, s10
    s_mov_b32 s25, s11
    s_mov_b32 s26, 1024
    s_mov_b32 s27, 0x00020000
    v_and_b32 v1, 63, v0
    v_lshrrev_b32 v2, 6, v0
    s_lshl_b32 s28, s2, 8
    v_lshlrev_b32 v3, 2, v1
    v_add_u32 v3, s28, v3
    v_lshlrev_b32 v4, 17, v2
    v_add_u32 v3, v3, v4
    v_add_u32 v4, 1048576, v3
    buffer_load_dword v16, v4, s[20:23], 0 offen
    buffer_load_dword v17, v4, s[20:23], 0 offen offset:2048
    v_add_u32 v4, 0x1000, v4
    buffer_load_dword v18, v4, s[20:23], 0 offen
    buffer_load_dword v19, v4, s[20:23], 0 offen offset:2048
    v_add_u32 v4, 0x1000, v4
    buffer_load_dword v20, v4, s[20:23], 0 offen
    buffer_load_dword v21, v4, s[20:23], 0 offen offset:2048
    v_add_u32 v4, 0x1000, v4
    buffer_load_dword v22, v4, s[20:23], 0 offen
    buffer_load_dword v23, v4, s[20:23], 0 offen offset:2048
    v_add_u32 v4, 0x1000, v4
    buffer_load_dword v24, v4, s[20:23], 0 offen
    buffer_load_dword v25, v4, s[20:23], 0 offen offset:2048
    v_add_u32 v4, 0x1000, v4
    buffer_load_dword v26, v4, s[20:23], 0 offen
    buffer_load_dword v27, v4, s[20:23], 0 offen offset:2048
    v_add_u32 v4, 0x1000, v4
    buffer_load_dword v28, v4, s[20:23], 0 offen
    buffer_load_dword v29, v4, s[20:23], 0 offen offset:2048
    v_add_u32 v4, 0x1000, v4
    buffer_load_dword v30, v4, s[20:23], 0 offen
    buffer_load_dword v31, v4, s[20:23], 0 offen offset:2048
    v_add_u32 v4, 0x1000, v4
    buffer_load_dword v32, v4, s[20:23], 0 offen
    buffer_load_dword v33, v4, s[20:23], 0 offen offset:2048
    v_add_u32 v4, 0x1000, v4
    buffer_load_dword v34, v4, s[20:23], 0 offen
    buffer_load_dword v35, v4, s[20:23], 0 offen offset:2048
    v_add_u32 v4, 0x1000, v4
    buffer_load_dword v36, v4, s[20:23], 0 offen
    buffer_load_dword v37, v4, s[20:23], 0 offen offset:2048
    v_add_u32 v4, 0x1000, v4
    buffer_load_dword v38, v4, s[20:23], 0 offen
    buffer_load_dword v39, v4, s[20:23], 0 offen offset:2048
    v_add_u32 v4, 0x1000, v4
    buffer_load_dword v40, v4, s[20:23], 0 offen
    buffer_load_dword v41, v4, s[20:23], 0 offen offset:2048
    v_add_u32 v4, 0x1000, v4
    buffer_load_dword v42, v4, s[20:23], 0 offen
    buffer_load_dword v43, v4, s[20:23], 0 offen offset:2048
    v_add_u32 v4, 0x1000, v4
    buffer_load_dword v44, v4, s[20:23], 0 offen
    buffer_load_dword v45, v4, s[20:23], 0 offen offset:2048
    v_add_u32 v4, 0x1000, v4
    buffer_load_dword v46, v4, s[20:23], 0 offen
    buffer_load_dword v47, v4, s[20:23], 0 offen offset:2048
    v_add_u32 v4, 0x1000, v4
    buffer_load_dword v48, v4, s[20:23], 0 offen
    buffer_load_dword v49, v4, s[20:23], 0 offen offset:2048
    v_add_u32 v4, 0x1000, v4
    buffer_load_dword v50, v4, s[20:23], 0 offen
    buffer_load_dword v51, v4, s[20:23], 0 offen offset:2048
    v_add_u32 v4, 0x1000, v4
    buffer_load_dword v52, v4, s[20:23], 0 offen
    buffer_load_dword v53, v4, s[20:23], 0 offen offset:2048
    v_add_u32 v4, 0x1000, v4
    buffer_load_dword v54, v4, s[20:23], 0 offen
    buffer_load_dword v55, v4, s[20:23], 0 offen offset:2048
    v_add_u32 v4, 0x1000, v4
    buffer_load_dword v56, v4, s[20:23], 0 offen
    buffer_load_dword v57, v4, s[20:23], 0 offen offset:2048
    v_add_u32 v4, 0x1000, v4
    buffer_load_dword v58, v4, s[20:23], 0 offen
    buffer_load_dword v59, v4, s[20:23], 0 offen offset:2048
    v_add_u32 v4, 0x1000, v4
    buffer_load_dword v60, v4, s[20:23], 0 offen
    buffer_load_dword v61, v4, s[20:23], 0 offen offset:2048
    v_add_u32 v4, 0x1000, v4
    buffer_load_dword v62, v4, s[20:23], 0 offen
    buffer_load_dword v63, v4, s[20:23], 0 offen offset:2048
    v_add_u32 v4, 0x1000, v4
    buffer_load_dword v64, v4, s[20:23], 0 offen
    buffer_load_dword v65, v4, s[20:23], 0 offen offset:2048
    v_add_u32 v4, 0x1000, v4
    buffer_load_dword v66, v4, s[20:23], 0 offen
    buffer_load_dword v67, v4, s[20:23], 0 offen offset:2048
    v_add_u32 v4, 0x1000, v4
    buffer_load_dword v68, v4, s[20:23], 0 offen
    buffer_load_dword v69, v4, s[20:23], 0 offen offset:2048
    v_add_u32 v4, 0x1000, v4
    buffer_load_dword v70, v4, s[20:23], 0 offen
    buffer_load_dword v71, v4, s[20:23], 0 offen offset:2048
    v_add_u32 v4, 0x1000, v4
    buffer_load_dword v72, v4, s[20:23], 0 offen
    buffer_load_dword v73, v4, s[20:23], 0 offen offset:2048
    v_add_u32 v4, 0x1000, v4
    buffer_load_dword v74, v4, s[20:23], 0 offen
    buffer_load_dword v75, v4, s[20:23], 0 offen offset:2048
    v_add_u32 v4, 0x1000, v4
    buffer_load_dword v76, v4, s[20:23], 0 offen
    buffer_load_dword v77, v4, s[20:23], 0 offen offset:2048
    v_add_u32 v4, 0x1000, v4
    buffer_load_dword v78, v4, s[20:23], 0 offen
    buffer_load_dword v79, v4, s[20:23], 0 offen offset:2048
    v_add_u32 v4, 1572864, v3
    buffer_load_dword v80, v4, s[20:23], 0 offen
    buffer_load_dword v81, v4, s[20:23], 0 offen offset:2048
    v_add_u32 v4, 0x1000, v4
    buffer_load_dword v82, v4, s[20:23], 0 offen
    buffer_load_dword v83, v4, s[20:23], 0 offen offset:2048
    v_add_u32 v4, 0x1000, v4
    buffer_load_dword v84, v4, s[20:23], 0 offen
    buffer_load_dword v85, v4, s[20:23], 0 offen offset:2048
    v_add_u32 v4, 0x1000, v4
    buffer_load_dword v86, v4, s[20:23], 0 offen
    buffer_load_dword v87, v4, s[20:23], 0 offen offset:2048
    v_add_u32 v4, 0x1000, v4
    buffer_load_dword v88, v4, s[20:23], 0 offen
    buffer_load_dword v89, v4, s[20:23], 0 offen offset:2048
    v_add_u32 v4, 0x1000, v4
    buffer_load_dword v90, v4, s[20:23], 0 offen
    buffer_load_dword v91, v4, s[20:23], 0 offen offset:2048
    v_add_u32 v4, 0x1000, v4
    buffer_load_dword v92, v4, s[20:23], 0 offen
    buffer_load_dword v93, v4, s[20:23], 0 offen offset:2048
    v_add_u32 v4, 0x1000, v4
    buffer_load_dword v94, v4, s[20:23], 0 offen
    buffer_load_dword v95, v4, s[20:23], 0 offen offset:2048
    v_add_u32 v4, 0x1000, v4
    buffer_load_dword v96, v4, s[20:23], 0 offen
    buffer_load_dword v97, v4, s[20:23], 0 offen offset:2048
    v_add_u32 v4, 0x1000, v4
    buffer_load_dword v98, v4, s[20:23], 0 offen
    buffer_load_dword v99, v4, s[20:23], 0 offen offset:2048
    v_add_u32 v4, 0x1000, v4
    buffer_load_dword v100, v4, s[20:23], 0 offen
    buffer_load_dword v101, v4, s[20:23], 0 offen offset:2048
    v_add_u32 v4, 0x1000, v4
    buffer_load_dword v102, v4, s[20:23], 0 offen
    buffer_load_dword v103, v4, s[20:23], 0 offen offset:2048
    v_add_u32 v4, 0x1000, v4
    buffer_load_dword v104, v4, s[20:23], 0 offen
    buffer_load_dword v105, v4, s[20:23], 0 offen offset:2048
    v_add_u32 v4, 0x1000, v4
    buffer_load_dword v106, v4, s[20:23], 0 offen
    buffer_load_dword v107, v4, s[20:23], 0 offen offset:2048
    v_add_u32 v4, 0x1000, v4
    buffer_load_dword v108, v4, s[20:23], 0 offen
    buffer_load_dword v109, v4, s[20:23], 0 offen offset:2048
    v_add_u32 v4, 0x1000, v4
    buffer_load_dword v110, v4, s[20:23], 0 offen
    buffer_load_dword v111, v4, s[20:23], 0 offen offset:2048
    v_add_u32 v4, 0x1000, v4
    buffer_load_dword v112, v4, s[20:23], 0 offen
    buffer_load_dword v113, v4, s[20:23], 0 offen offset:2048
    v_add_u32 v4, 0x1000, v4
    buffer_load_dword v114, v4, s[20:23], 0 offen
    buffer_load_dword v115, v4, s[20:23], 0 offen offset:2048
    v_add_u32 v4, 0x1000, v4
    buffer_load_dword v116, v4, s[20:23], 0 offen
    buffer_load_dword v117, v4, s[20:23], 0 offen offset:2048
    v_add_u32 v4, 0x1000, v4
    buffer_load_dword v118, v4, s[20:23], 0 offen
    buffer_load_dword v119, v4, s[20:23], 0 offen offset:2048
    v_add_u32 v4, 0x1000, v4
    buffer_load_dword v120, v4, s[20:23], 0 offen
    buffer_load_dword v121, v4, s[20:23], 0 offen offset:2048
    v_add_u32 v4, 0x1000, v4
    buffer_load_dword v122, v4, s[20:23], 0 offen
    buffer_load_dword v123, v4, s[20:23], 0 offen offset:2048
    v_add_u32 v4, 0x1000, v4
    buffer_load_dword v124, v4, s[20:23], 0 offen
    buffer_load_dword v125, v4, s[20:23], 0 offen offset:2048
    v_add_u32 v4, 0x1000, v4
    buffer_load_dword v126, v4, s[20:23], 0 offen
    buffer_load_dword v127, v4, s[20:23], 0 offen offset:2048
    v_add_u32 v4, 0x1000, v4
    buffer_load_dword v128, v4, s[20:23], 0 offen
    buffer_load_dword v129, v4, s[20:23], 0 offen offset:2048
    v_add_u32 v4, 0x1000, v4
    buffer_load_dword v130, v4, s[20:23], 0 offen
    buffer_load_dword v131, v4, s[20:23], 0 offen offset:2048
    v_add_u32 v4, 0x1000, v4
    buffer_load_dword v132, v4, s[20:23], 0 offen
    buffer_load_dword v133, v4, s[20:23], 0 offen offset:2048
    v_add_u32 v4, 0x1000, v4
    buffer_load_dword v134, v4, s[20:23], 0 offen
    buffer_load_dword v135, v4, s[20:23], 0 offen offset:2048
    v_add_u32 v4, 0x1000, v4
    buffer_load_dword v136, v4, s[20:23], 0 offen
    buffer_load_dword v137, v4, s[20:23], 0 offen offset:2048
    v_add_u32 v4, 0x1000, v4
    buffer_load_dword v138, v4, s[20:23], 0 offen
    buffer_load_dword v139, v4, s[20:23], 0 offen offset:2048
    v_add_u32 v4, 0x1000, v4
    buffer_load_dword v140, v4, s[20:23], 0 offen
    buffer_load_dword v141, v4, s[20:23], 0 offen offset:2048
    v_add_u32 v4, 0x1000, v4
    buffer_load_dword v142, v4, s[20:23], 0 offen
    buffer_load_dword v143, v4, s[20:23], 0 offen offset:2048
    s_waitcnt vmcnt(0)
    v_add_f32 v16, v16, v17
    v_add_f32 v16, v16, v18
    v_add_f32 v16, v16, v19
    v_add_f32 v16, v16, v20
    v_add_f32 v16, v16, v21
    v_add_f32 v16, v16, v22
    v_add_f32 v16, v16, v23
    v_add_f32 v16, v16, v24
    v_add_f32 v16, v16, v25
    v_add_f32 v16, v16, v26
    v_add_f32 v16, v16, v27
    v_add_f32 v16, v16, v28
    v_add_f32 v16, v16, v29
    v_add_f32 v16, v16, v30
    v_add_f32 v16, v16, v31
    v_add_f32 v16, v16, v32
    v_add_f32 v16, v16, v33
    v_add_f32 v16, v16, v34
    v_add_f32 v16, v16, v35
    v_add_f32 v16, v16, v36
    v_add_f32 v16, v16, v37
    v_add_f32 v16, v16, v38
    v_add_f32 v16, v16, v39
    v_add_f32 v16, v16, v40
    v_add_f32 v16, v16, v41
    v_add_f32 v16, v16, v42
    v_add_f32 v16, v16, v43
    v_add_f32 v16, v16, v44
    v_add_f32 v16, v16, v45
    v_add_f32 v16, v16, v46
    v_add_f32 v16, v16, v47
    v_add_f32 v16, v16, v48
    v_add_f32 v16, v16, v49
    v_add_f32 v16, v16, v50
    v_add_f32 v16, v16, v51
    v_add_f32 v16, v16, v52
    v_add_f32 v16, v16, v53
    v_add_f32 v16, v16, v54
    v_add_f32 v16, v16, v55
    v_add_f32 v16, v16, v56
    v_add_f32 v16, v16, v57
    v_add_f32 v16, v16, v58
    v_add_f32 v16, v16, v59
    v_add_f32 v16, v16, v60
    v_add_f32 v16, v16, v61
    v_add_f32 v16, v16, v62
    v_add_f32 v16, v16, v63
    v_add_f32 v16, v16, v64
    v_add_f32 v16, v16, v65
    v_add_f32 v16, v16, v66
    v_add_f32 v16, v16, v67
    v_add_f32 v16, v16, v68
    v_add_f32 v16, v16, v69
    v_add_f32 v16, v16, v70
    v_add_f32 v16, v16, v71
    v_add_f32 v16, v16, v72
    v_add_f32 v16, v16, v73
    v_add_f32 v16, v16, v74
    v_add_f32 v16, v16, v75
    v_add_f32 v16, v16, v76
    v_add_f32 v16, v16, v77
    v_add_f32 v16, v16, v78
    v_add_f32 v16, v16, v79
    v_add_f32 v80, v80, v81
    v_add_f32 v80, v80, v82
    v_add_f32 v80, v80, v83
    v_add_f32 v80, v80, v84
    v_add_f32 v80, v80, v85
    v_add_f32 v80, v80, v86
    v_add_f32 v80, v80, v87
    v_add_f32 v80, v80, v88
    v_add_f32 v80, v80, v89
    v_add_f32 v80, v80, v90
    v_add_f32 v80, v80, v91
    v_add_f32 v80, v80, v92
    v_add_f32 v80, v80, v93
    v_add_f32 v80, v80, v94
    v_add_f32 v80, v80, v95
    v_add_f32 v80, v80, v96
    v_add_f32 v80, v80, v97
    v_add_f32 v80, v80, v98
    v_add_f32 v80, v80, v99
    v_add_f32 v80, v80, v100
    v_add_f32 v80, v80, v101
    v_add_f32 v80, v80, v102
    v_add_f32 v80, v80, v103
    v_add_f32 v80, v80, v104
    v_add_f32 v80, v80, v105
    v_add_f32 v80, v80, v106
    v_add_f32 v80, v80, v107
    v_add_f32 v80, v80, v108
    v_add_f32 v80, v80, v109
    v_add_f32 v80, v80, v110
    v_add_f32 v80, v80, v111
    v_add_f32 v80, v80, v112
    v_add_f32 v80, v80, v113
    v_add_f32 v80, v80, v114
    v_add_f32 v80, v80, v115
    v_add_f32 v80, v80, v116
    v_add_f32 v80, v80, v117
    v_add_f32 v80, v80, v118
    v_add_f32 v80, v80, v119
    v_add_f32 v80, v80, v120
    v_add_f32 v80, v80, v121
    v_add_f32 v80, v80, v122
    v_add_f32 v80, v80, v123
    v_add_f32 v80, v80, v124
    v_add_f32 v80, v80, v125
    v_add_f32 v80, v80, v126
    v_add_f32 v80, v80, v127
    v_add_f32 v80, v80, v128
    v_add_f32 v80, v80, v129
    v_add_f32 v80, v80, v130
    v_add_f32 v80, v80, v131
    v_add_f32 v80, v80, v132
    v_add_f32 v80, v80, v133
    v_add_f32 v80, v80, v134
    v_add_f32 v80, v80, v135
    v_add_f32 v80, v80, v136
    v_add_f32 v80, v80, v137
    v_add_f32 v80, v80, v138
    v_add_f32 v80, v80, v139
    v_add_f32 v80, v80, v140
    v_add_f32 v80, v80, v141
    v_add_f32 v80, v80, v142
    v_add_f32 v80, v80, v143
    v_lshlrev_b32 v4, 2, v0
    ds_write_b32 v4, v16
    ds_write_b32 v4, v80 offset:1024
    s_waitcnt lgkmcnt(0)
    s_barrier
    v_cmp_gt_u32 vcc, 64, v0
    s_and_saveexec_b64 s[30:31], vcc
    s_cbranch_execz K4_END
    ds_read_b32 v16, v4 offset:0
    ds_read_b32 v20, v4 offset:1024
    ds_read_b32 v17, v4 offset:256
    ds_read_b32 v21, v4 offset:1280
    ds_read_b32 v18, v4 offset:512
    ds_read_b32 v22, v4 offset:1536
    ds_read_b32 v19, v4 offset:768
    ds_read_b32 v23, v4 offset:1792
    s_lshl_b32 s28, s2, 7
    v_lshlrev_b32 v5, 1, v0
    v_add_u32 v5, s28, v5
    buffer_load_ushort v24, v5, s[12:15], 0 offen
    buffer_load_ushort v25, v5, s[16:19], 0 offen
    s_waitcnt vmcnt(0) lgkmcnt(0)
    v_add_f32 v16, v16, v17
    v_add_f32 v20, v20, v21
    v_add_f32 v16, v16, v18
    v_add_f32 v20, v20, v22
    v_add_f32 v16, v16, v19
    v_add_f32 v20, v20, v23
    v_lshlrev_b32 v24, 16, v24
    v_lshlrev_b32 v25, 16, v25
    v_add_f32 v20, v20, v25
    v_mul_f32 v21, 0xbfb8aa3b, v20
    v_exp_f32 v21, v21
    s_nop 0
    v_add_f32 v21, 1.0, v21
    v_rcp_f32 v21, v21
    s_nop 0
    v_mul_f32 v20, v20, v21
    v_fma_f32 v16, v16, v20, v24
    v_bfe_u32 v17, v16, 16, 1
    v_add3_u32 v16, v16, v17, s40
    v_and_b32 v16, 0xffff0000, v16
    v_lshrrev_b32 v16, 16, v16
    buffer_store_short v16, v5, s[24:27], 0 offen
K4_END:
    s_endpgm
.section .rodata,"a"
.p2align 6
.amdhsa_kernel prep_kernel
  .amdhsa_next_free_vgpr 96
  .amdhsa_next_free_sgpr 102
  .amdhsa_accum_offset 96
  .amdhsa_group_segment_fixed_size 0
  .amdhsa_kernarg_size 104
  .amdhsa_user_sgpr_count 2
  .amdhsa_user_sgpr_kernarg_segment_ptr 1
  .amdhsa_system_sgpr_workgroup_id_x 1
.end_amdhsa_kernel
.amdhsa_kernel attn_kernel
  .amdhsa_next_free_vgpr 256
  .amdhsa_next_free_sgpr 102
  .amdhsa_accum_offset 256
  .amdhsa_group_segment_fixed_size 0
  .amdhsa_kernarg_size 104
  .amdhsa_user_sgpr_count 2
  .amdhsa_user_sgpr_kernarg_segment_ptr 1
  .amdhsa_system_sgpr_workgroup_id_x 1
.end_amdhsa_kernel
.amdhsa_kernel comb_kernel
  .amdhsa_next_free_vgpr 128
  .amdhsa_next_free_sgpr 102
  .amdhsa_accum_offset 128
  .amdhsa_group_segment_fixed_size 0
  .amdhsa_kernarg_size 104
  .amdhsa_user_sgpr_count 2
  .amdhsa_user_sgpr_kernarg_segment_ptr 1
  .amdhsa_system_sgpr_workgroup_id_x 1
.end_amdhsa_kernel
.amdhsa_kernel final_kernel
  .amdhsa_next_free_vgpr 144
  .amdhsa_next_free_sgpr 102
  .amdhsa_accum_offset 144
  .amdhsa_group_segment_fixed_size 0
  .amdhsa_kernarg_size 104
  .amdhsa_user_sgpr_count 2
  .amdhsa_user_sgpr_kernarg_segment_ptr 1
  .amdhsa_system_sgpr_workgroup_id_x 1
.end_amdhsa_kernel
```
